```python
import torch

def _softmax(x, axis=-1):
    return torch.softmax(x, dim=axis)
def _gelu(x):
    return torch.nn.functional.gelu(x, approximate="tanh")
def _silu(x):
    return torch.nn.functional.silu(x)
def _sigmoid(x):
    return torch.sigmoid(x)
def _layernorm(x, axis=-1, eps=1e-5):
    m = x.mean(dim=axis, keepdim=True)
    v = x.var(dim=axis, keepdim=True, unbiased=False)
    return (x - m) / torch.sqrt(v + eps)
def _scatter_add(tgt, idx, src, axis=0):
    return tgt.clone().index_add_(axis, idx, src)
def _segment_sum(src, seg, n):
    out = torch.zeros((n,) + src.shape[1:], dtype=src.dtype)
    return out.index_add_(0, seg, src)
def _pad(x, pw):
    flat = tuple(v for pair in reversed(pw) for v in pair)
    return torch.nn.functional.pad(x, flat)

kernel_name = 'concat_heads__spectral_fnet__softmax_full_mha__prompt'

def setup_inputs():

    _w = (lambda a: (lambda t: t.to(torch.bfloat16) if t.is_floating_point() else t)(torch.as_tensor(a)))
    def _A_setup():
        B, S, D = 1, 2048, 512
        ns = torch.arange(S)[:, None] * torch.arange(S)[None, :]
        nd = torch.arange(D)[:, None] * torch.arange(D)[None, :]
        Ws_re = torch.cos(-2.0 * torch.pi * ns / S).to(float)
        Ws_im = torch.sin(-2.0 * torch.pi * ns / S).to(float)
        Wd_re = torch.cos(-2.0 * torch.pi * nd / D).to(float)
        Wd_im = torch.sin(-2.0 * torch.pi * nd / D).to(float)
        return {
            "x": _w((lambda *s: torch.randn(*s, dtype=torch.bfloat16) * 0.05)(B, S, D)),
            "dft_seq_re": _w(Ws_re),
            "dft_seq_im": _w(Ws_im),
            "dft_hid_re": _w(Wd_re),
            "dft_hid_im": _w(Wd_im),
        }
    _A_in = _A_setup()

    def _B_setup():
        B, S, D = 1, 2048, 512
        return {
            "x": _w((lambda *s: torch.randn(*s, dtype=torch.bfloat16) * 0.2)(B, S, D)),
            "wqkv": _w((lambda *s: torch.randn(*s, dtype=torch.bfloat16) * 0.8)(D, 3 * D)),
            "wo": _w((lambda *s: torch.randn(*s, dtype=torch.bfloat16) * 0.2)(D, D)),
        }
    _B_in = _B_setup()

    return {
        "A_x": _A_in["x"],
        "A_dft_seq_re": _A_in["dft_seq_re"],
        "A_dft_seq_im": _A_in["dft_seq_im"],
        "A_dft_hid_re": _A_in["dft_hid_re"],
        "A_dft_hid_im": _A_in["dft_hid_im"],
        "B_x": _B_in["x"],
        "B_wqkv": _B_in["wqkv"],
        "B_wo": _B_in["wo"],
    }

def reference(A_x, A_dft_seq_re, A_dft_seq_im, A_dft_hid_re, A_dft_hid_im, B_x, B_wqkv, B_wo):
    def _A_ref(x, dft_seq_re, dft_seq_im, dft_hid_re, dft_hid_im):
        a = torch.einsum("bsd,ed->bse", x, dft_hid_re)
        b = torch.einsum("bsd,ed->bse", x, dft_hid_im)
        y = torch.einsum("ts,bse->bte", dft_seq_re, a) - torch.einsum("ts,bse->bte", dft_seq_im, b)
        return y

    def _B_ref(x, wqkv, wo):
        B, S, D = x.shape
        H = 32; Dh = D // H
        qkv = (lambda x, *d: x.permute(*d))((x @ wqkv).reshape(B, S, 3, H, Dh), 2, 0, 3, 1, 4)
        q, k, v = qkv[0], qkv[1], qkv[2]
        scale = Dh ** -0.5
        scores = torch.einsum("bhqd,bhkd->bhqk", q, k) * scale
        p = _softmax(scores, axis=-1)
        o = torch.einsum("bhqk,bhkd->bhqd", p, v)
        return (lambda x, *d: x.permute(*d))(o, 0, 2, 1, 3).reshape(B, S, D) @ wo

    a = _A_ref(A_x, A_dft_seq_re, A_dft_seq_im, A_dft_hid_re, A_dft_hid_im)
    b = _B_ref(B_x, B_wqkv, B_wo)
    return torch.concatenate([a, b], axis=-1)
```

```asm
; @launch grid=(256,1,1) block=(512,1,1) lds=163840
.amdgcn_target "amdgcn-amd-amdhsa--gfx950"
.text
.globl concat_heads__spectral_fnet__softmax_full_mha__prompt_kernel
.p2align 8
.type concat_heads__spectral_fnet__softmax_full_mha__prompt_kernel,@function
concat_heads__spectral_fnet__softmax_full_mha__prompt_kernel:
    s_cmp_ge_u32 s2, 256
    s_cbranch_scc1 L_end
    s_load_dwordx16 s[36:51], s[0:1], 0
    s_load_dwordx4 s[52:55], s[0:1], 64
    s_load_dwordx2 s[56:57], s[0:1], 80
    v_lshrrev_b32 v1, 6, v0
    v_and_b32 v0, 63, v0
    v_readfirstlane_b32 s3, v1
    s_and_b32 s60, s2, 7
    s_lshr_b32 s61, s2, 3
    s_cmp_eq_u32 s3, 0
    s_cbranch_scc0 L_nopf
    v_min_u32 v22, 5, v0
    v_lshl_add_u32 v22, v22, 5, s61
    v_lshlrev_b32 v22, 7, v22
    v_min_u32 v22, L_code_end - L_pc - 4, v22
    s_getpc_b64 s[6:7]
L_pc:
    global_load_dword v23, v22, s[6:7]
L_nopf:
    s_lshr_b32 s62, s60, 1
    s_and_b32 s63, s60, 1
    s_lshl_b32 s63, s63, 3
    s_and_b32 s4, s61, 7
    s_add_u32 s63, s63, s4
    s_lshr_b32 s64, s61, 3
    s_lshl_b32 s65, s64, 0
    s_add_u32 s65, s65, s4
    s_cmp_eq_u32 s62, 3
    s_cselect_b32 s66, 1, 3
    s_lshl_b32 s14, s66, 19
    s_lshl_b32 s66, s66, 10
    s_lshl_b32 s6, s62, 10
    s_lshl_b32 s7, s64, 8
    s_add_u32 s6, s6, s7
    s_and_b32 s7, s7, 256
    s_cmp_eq_u32 s62, 3
    s_cselect_b32 s67, s7, s6
    s_mov_b32 s10, 0x200000
    s_mov_b32 s11, 0x20000
    s_mov_b32 s15, 0x20000
    s_cmp_ge_u32 s3, 4
    s_cbranch_scc0 L_p1_compute
    s_sub_u32 s68, s3, 4
    v_lshrrev_b32 v1, 3, v0
    v_and_b32 v2, 7, v0
    v_lshrrev_b32 v3, 4, v0
    v_xor_b32 v2, v2, v3
    v_lshlrev_b32 v2, 4, v2
    v_xor_b32 v9, 64, v2
    s_cmp_eq_u32 s62, 3
    s_cbranch_scc1 L_p1_rowsA
    s_lshl_b32 s4, s63, 7
    s_lshl_b32 s5, s68, 5
    s_add_u32 s4, s4, s5
    v_add_u32 v1, s4, v1
    v_lshl_add_u32 v4, v1, 10, v2
    v_lshl_add_u32 v5, v1, 10, v9
    v_add_u32 v5, 0x1c00, v5
    v_add_u32 v6, 0x3800, v4
    v_add_u32 v7, 0x3800, v5
L_p1_rowsdone:
    v_and_b32 v2, 15, v0
    v_lshlrev_b32 v9, 2, v3
    v_xor_b32 v2, v2, v9
    v_lshlrev_b32 v2, 4, v2
    s_lshl_b32 s4, s68, 4
    v_add_u32 v3, s4, v3
    v_mul_lo_u32 v3, v3, s66
    v_add3_u32 v8, v3, v2, s67
    v_xor_b32 v9, 32, v8
    s_lshl_b32 s72, s66, 2
    s_sub_u32 s72, s72, 1024
    s_lshl_b32 s73, s66, 6
    s_lshl_b32 s74, s68, 12
    s_waitcnt lgkmcnt(0)
    s_cmp_lt_u32 s64, 2
    s_cselect_b32 s4, s42, s44
    s_cselect_b32 s5, s43, s45
    s_cmp_eq_u32 s62, 3
    s_cselect_b32 s8, s36, s46
    s_cselect_b32 s9, s37, s47
    s_cselect_b32 s12, s4, s48
    s_cselect_b32 s13, s5, s49
    s_and_b32 s4, s65, 3
    s_add_u32 m0, s74, 0
    s_lshl_b32 s5, s4, 7
    buffer_load_dwordx4 v4, s[8:11], s5 offen offset:0 lds
    buffer_load_dwordx4 v5, s[8:11], s5 offen offset:1024 lds
    buffer_load_dwordx4 v6, s[8:11], s5 offen offset:2048 lds
    buffer_load_dwordx4 v7, s[8:11], s5 offen offset:3072 lds
    s_add_u32 m0, s74, 16384
    s_mul_i32 s6, s4, s73
    buffer_load_dwordx4 v8, s[12:15], s6 offen offset:0 lds
    s_add_u32 s6, s6, s72
    buffer_load_dwordx4 v8, s[12:15], s6 offen offset:1024 lds
    s_add_u32 s6, s6, s72
    buffer_load_dwordx4 v9, s[12:15], s6 offen offset:2048 lds
    s_add_u32 s6, s6, s72
    buffer_load_dwordx4 v9, s[12:15], s6 offen offset:3072 lds
    s_branch L_p1_rowsskip
L_p1_rowsA:
    s_lshl_b32 s4, s63, 5
    s_lshr_b32 s5, s68, 1
    s_lshl_b32 s5, s5, 4
    s_add_u32 s4, s4, s5
    v_add_u32 v1, s4, v1
    s_and_b32 s5, s68, 1
    s_lshl_b32 s6, s5, 10
    s_lshl_b32 s7, s5, 9
    v_cmp_eq_u32 vcc, 0, v1
    v_mov_b32 v10, s7
    v_add_u32 v11, s6, v1
    v_cndmask_b32 v10, 0, v10, vcc
    s_add_u32 s6, s6, 1024
    v_sub_u32 v12, s6, v1
    v_add_u32 v13, 7, v11
    v_subrev_u32 v14, 11, v12
    v_sub_u32 v11, v11, v10
    v_sub_u32 v12, v12, v10
    v_subrev_u32 v12, 2, v12
    v_lshl_add_u32 v4, v11, 10, v2
    v_lshl_add_u32 v5, v13, 10, v9
    v_lshl_add_u32 v6, v12, 10, v2
    v_lshl_add_u32 v7, v14, 10, v9
    s_branch L_p1_rowsdone
L_p1_rowsskip:
    v_mov_b32 v122, v0
    v_lshlrev_b32 v120, 4, v0
    v_mov_b32 v224, 2.0
    v_mov_b32 v225, 2.0
    s_mov_b32 s75, 0
    s_mov_b32 s92, 0
    s_and_b32 s4, s61, 7
    s_lshl_b32 s76, s60, 2
    s_and_b32 s5, s61, 3
    s_add_u32 s76, s76, s5
    s_lshr_b32 s77, s61, 2
    s_and_b32 s78, s3, 3
    s_lshr_b32 s79, s3, 2
    s_lshl_b32 s80, s60, 3
    s_add_u32 s80, s80, s4
    s_mov_b32 s81, s64
    s_mov_b32 s16, s56
    s_mov_b32 s17, s57
    s_mov_b32 s18, 11534336
    s_mov_b32 s19, 0x20000
    s_mov_b32 s32, s50
    s_mov_b32 s33, s51
    s_mov_b32 s34, 524288
    s_mov_b32 s35, 0x20000
    s_add_u32 s4, s56, 10092544
    s_addc_u32 s5, s57, 0
    s_load_dword s58, s[4:5], 0
    s_lshl_b32 s4, s77, 3
    s_lshl_b32 s5, s78, 1
    s_add_u32 s4, s4, s5
    s_add_u32 s4, s4, s79
    s_lshl_b32 s4, s4, 15
    s_lshl_b32 s5, s76, 10
    s_add_u32 s4, s4, s5
    s_add_u32 s82, s4, 7340032
    v_and_b32 v1, 11, v0
    v_cmp_eq_u32 vcc, 0, v1
    v_mov_b32 v2, 1400918912
    s_mul_i32 s4, s68, 2560
    v_cndmask_b32 v16, 0, v2, vcc
    v_mov_b32 v17, v16
    v_mov_b32 v18, v16
    v_mov_b32 v19, v16
    s_add_u32 s4, s4, 131072
    v_add_u32 v1, s4, v120
    ds_write_b128 v1, v[16:19]
    ds_write_b128 v1, v[16:19] offset:1024
    ds_write_b128 v1, v[16:19] offset:1536
    v_mov_b32 v1, 161792
    v_mov_b32 v2, 0
    ds_write2_b32 v1, v2, v2 offset1:1
    s_mov_b32 s20, s52
    s_mov_b32 s21, s53
    s_mov_b32 s22, 4194304
    s_mov_b32 s23, 0x20000
    s_mov_b32 s24, s38
    s_mov_b32 s25, s39
    s_mov_b32 s26, 8388608
    s_mov_b32 s27, 0x20000
    s_mov_b32 s28, s40
    s_mov_b32 s29, s41
    s_mov_b32 s30, 8388608
    s_mov_b32 s31, 0x20000
    s_lshl_b32 s4, s79, 16
    v_add_u32 v117, s4, v120
    v_add_u32 v2, 4, v122
    v_and_b32 v2, 8, v2
    v_lshrrev_b32 v2, 1, v2
    v_and_b32 v1, 11, v122
    v_min_u32 v1, 1, v1
    v_add_u32 v2, v1, v2
    v_and_b32 v1, 16, v122
    v_cmp_ne_u32 vcc, 0, v1
    s_mov_b32 s48, 0xffff
    s_mov_b32 s49, 0xffff
    v_lshlrev_b32 v2, 4, v2
    v_add_u32 v2, 131072, v2
    v_cndmask_b32 v118, v117, v2, vcc
    v_mov_b32 v2, 0x2000
    v_cndmask_b32 v119, v2, 0, vcc
    v_mov_b32 v116, 0xdddddddd
    v_and_b32 v1, 31, v122
    s_and_b32 s4, s76, 15
    s_lshl_b32 s4, s4, 6
    s_lshr_b32 s83, s76, 4
    s_add_u32 s84, s4, s83
    v_lshl_add_u32 v1, v1, 1, s84
    v_lshlrev_b32 v1, 12, v1
    v_lshrrev_b32 v2, 5, v122
    v_lshl_add_u32 v1, v2, 4, v1
    s_lshl_b32 s4, s3, 7
    v_add_u32 v121, s4, v1
    s_lshl_b32 s85, s83, 18
    s_lshl_b32 s4, s77, 15
    s_add_u32 s85, s85, s4
    s_lshl_b32 s4, s3, 12
    s_add_u32 s85, s85, s4
    s_add_u32 s85, s85, 6291456
    s_add_u32 s86, s85, 0x80000
    s_lshl_b32 s87, s81, 3
    s_add_u32 s87, s87, s3
    s_lshl_b32 s87, s87, 14
    s_add_u32 s87, s87, 9437184
    s_lshl_b32 s88, s76, 17
    s_add_u32 s88, s88, 2097152
    s_lshl_b32 s4, s79, 16
    s_add_u32 s89, s88, s4
    s_lshl_b32 s91, s78, 11
    s_add_u32 s90, s89, s91
    s_add_u32 s5, s91, 141312
    v_add_u32 v123, s5, v120
    s_add_u32 s91, s91, s4
    s_lshl_b32 s4, s64, 6
    s_lshl_b32 s5, s62, 4
    s_add_u32 s4, s4, s5
    s_add_u32 s4, s4, s63
    s_lshl_b32 s4, s4, 4
    s_add_u32 s93, s4, 10027008
    s_lshr_b32 s4, s76, 3
    s_lshl_b32 s4, s4, 5
    s_add_u32 s4, s4, s61
    s_lshl_b32 s4, s4, 11
    s_add_u32 s55, s4, 10485760
    s_and_b32 s4, s63, 7
    s_lshl_b32 s5, s4, 7
    s_and_b32 s6, s63, 8
    s_add_u32 s5, s5, s6
    s_lshl_b32 s6, s62, 2
    s_add_u32 s5, s5, s6
    s_lshl_b32 s6, s64, 16
    s_add_u32 s5, s5, s6
    s_add_u32 s5, s5, 10485756
    s_cmp_ge_u32 s4, 4
    s_cselect_b32 s4, s62, 0
    s_sub_u32 s4, s4, 1
    s_cmp_lt_u32 s4, 2
    s_cselect_b32 s54, s5, 0
    v_mov_b64 v[64:65], 0
    v_mov_b64 v[66:67], 0
    v_mov_b64 v[68:69], 0
    v_mov_b64 v[70:71], 0
    v_mov_b64 v[72:73], 0
    v_mov_b64 v[74:75], 0
    v_mov_b64 v[76:77], 0
    v_mov_b64 v[78:79], 0
    v_mov_b64 v[80:81], 0
    v_mov_b64 v[82:83], 0
    v_mov_b64 v[84:85], 0
    v_mov_b64 v[86:87], 0
    v_mov_b64 v[88:89], 0
    v_mov_b64 v[90:91], 0
    v_mov_b64 v[92:93], 0
    v_mov_b64 v[94:95], 0
    s_lshr_b32 s4, s61, 2
    s_and_b32 s4, s4, 3
    s_lshl_b32 s4, s4, 2
    s_lshr_b32 s59, 9252, s4
    s_and_b32 s59, s59, 7
    s_and_b32 s75, s65, 3
    s_or_b32 s75, s75, 4
    s_cmp_ge_u32 s59, 1
    s_addc_u32 s4, s65, 0
    s_and_b32 s4, s4, 3
    s_cmp_eq_u32 s59, 1
    s_cselect_b32 s4, s75, s4
    s_add_u32 m0, s74, 32768
    s_lshl_b32 s5, s4, 7
    buffer_load_dwordx4 v4, s[8:11], s5 offen offset:0 lds
    buffer_load_dwordx4 v5, s[8:11], s5 offen offset:1024 lds
    buffer_load_dwordx4 v6, s[8:11], s5 offen offset:2048 lds
    buffer_load_dwordx4 v7, s[8:11], s5 offen offset:3072 lds
    s_add_u32 m0, s74, 49152
    s_mul_i32 s6, s4, s73
    buffer_load_dwordx4 v8, s[12:15], s6 offen offset:0 lds
    s_add_u32 s6, s6, s72
    buffer_load_dwordx4 v8, s[12:15], s6 offen offset:1024 lds
    s_add_u32 s6, s6, s72
    buffer_load_dwordx4 v9, s[12:15], s6 offen offset:2048 lds
    s_add_u32 s6, s6, s72
    buffer_load_dwordx4 v9, s[12:15], s6 offen offset:3072 lds
    s_waitcnt vmcnt(8)
    s_barrier
    s_cmp_ge_u32 s59, 2
    s_addc_u32 s4, s65, 1
    s_and_b32 s4, s4, 3
    s_cmp_eq_u32 s59, 2
    s_cselect_b32 s4, s75, s4
    s_add_u32 m0, s74, 65536
    s_lshl_b32 s5, s4, 7
    buffer_load_dwordx4 v4, s[8:11], s5 offen offset:0 lds
    buffer_load_dwordx4 v5, s[8:11], s5 offen offset:1024 lds
    buffer_load_dwordx4 v6, s[8:11], s5 offen offset:2048 lds
    buffer_load_dwordx4 v7, s[8:11], s5 offen offset:3072 lds
    s_add_u32 m0, s74, 81920
    s_mul_i32 s6, s4, s73
    buffer_load_dwordx4 v8, s[12:15], s6 offen offset:0 lds
    s_add_u32 s6, s6, s72
    buffer_load_dwordx4 v8, s[12:15], s6 offen offset:1024 lds
    s_add_u32 s6, s6, s72
    buffer_load_dwordx4 v9, s[12:15], s6 offen offset:2048 lds
    s_add_u32 s6, s6, s72
    buffer_load_dwordx4 v9, s[12:15], s6 offen offset:3072 lds
    s_waitcnt vmcnt(8)
    s_barrier
    s_cmp_ge_u32 s59, 3
    s_addc_u32 s4, s65, 2
    s_and_b32 s4, s4, 3
    s_cmp_eq_u32 s59, 3
    s_cselect_b32 s4, s75, s4
    s_add_u32 m0, s74, 98304
    s_lshl_b32 s5, s4, 7
    buffer_load_dwordx4 v4, s[8:11], s5 offen offset:0 lds
    buffer_load_dwordx4 v5, s[8:11], s5 offen offset:1024 lds
    buffer_load_dwordx4 v6, s[8:11], s5 offen offset:2048 lds
    buffer_load_dwordx4 v7, s[8:11], s5 offen offset:3072 lds
    s_add_u32 m0, s74, 114688
    s_mul_i32 s6, s4, s73
    buffer_load_dwordx4 v8, s[12:15], s6 offen offset:0 lds
    s_add_u32 s6, s6, s72
    buffer_load_dwordx4 v8, s[12:15], s6 offen offset:1024 lds
    s_add_u32 s6, s6, s72
    buffer_load_dwordx4 v9, s[12:15], s6 offen offset:2048 lds
    s_add_u32 s6, s6, s72
    buffer_load_dwordx4 v9, s[12:15], s6 offen offset:3072 lds
    s_waitcnt vmcnt(8)
    s_barrier
    s_cmp_ge_u32 s59, 4
    s_addc_u32 s4, s65, 3
    s_and_b32 s4, s4, 3
    s_cmp_eq_u32 s59, 4
    s_cselect_b32 s4, s75, s4
    s_add_u32 m0, s74, 0
    s_lshl_b32 s5, s4, 7
    buffer_load_dwordx4 v4, s[8:11], s5 offen offset:0 lds
    buffer_load_dwordx4 v5, s[8:11], s5 offen offset:1024 lds
    buffer_load_dwordx4 v6, s[8:11], s5 offen offset:2048 lds
    buffer_load_dwordx4 v7, s[8:11], s5 offen offset:3072 lds
    s_add_u32 m0, s74, 16384
    s_mul_i32 s6, s4, s73
    buffer_load_dwordx4 v8, s[12:15], s6 offen offset:0 lds
    s_add_u32 s6, s6, s72
    buffer_load_dwordx4 v8, s[12:15], s6 offen offset:1024 lds
    s_add_u32 s6, s6, s72
    buffer_load_dwordx4 v9, s[12:15], s6 offen offset:2048 lds
    s_add_u32 s6, s6, s72
    buffer_load_dwordx4 v9, s[12:15], s6 offen offset:3072 lds
    s_waitcnt vmcnt(8)
    s_barrier
    s_add_u32 s4, s65, 5
    s_and_b32 s4, s4, 3
    s_or_b32 s4, s4, 4
    s_add_u32 m0, s74, 32768
    s_lshl_b32 s5, s4, 7
    buffer_load_dwordx4 v4, s[8:11], s5 offen offset:0 lds
    buffer_load_dwordx4 v5, s[8:11], s5 offen offset:1024 lds
    buffer_load_dwordx4 v6, s[8:11], s5 offen offset:2048 lds
    buffer_load_dwordx4 v7, s[8:11], s5 offen offset:3072 lds
    s_add_u32 m0, s74, 49152
    s_mul_i32 s6, s4, s73
    buffer_load_dwordx4 v8, s[12:15], s6 offen offset:0 lds
    s_add_u32 s6, s6, s72
    buffer_load_dwordx4 v8, s[12:15], s6 offen offset:1024 lds
    s_add_u32 s6, s6, s72
    buffer_load_dwordx4 v9, s[12:15], s6 offen offset:2048 lds
    s_add_u32 s6, s6, s72
    buffer_load_dwordx4 v9, s[12:15], s6 offen offset:3072 lds
    s_waitcnt vmcnt(8)
    s_barrier
    s_add_u32 s4, s65, 6
    s_and_b32 s4, s4, 3
    s_or_b32 s4, s4, 4
    s_add_u32 m0, s74, 65536
    s_lshl_b32 s5, s4, 7
    buffer_load_dwordx4 v4, s[8:11], s5 offen offset:0 lds
    buffer_load_dwordx4 v5, s[8:11], s5 offen offset:1024 lds
    buffer_load_dwordx4 v6, s[8:11], s5 offen offset:2048 lds
    buffer_load_dwordx4 v7, s[8:11], s5 offen offset:3072 lds
    s_add_u32 m0, s74, 81920
    s_mul_i32 s6, s4, s73
    buffer_load_dwordx4 v8, s[12:15], s6 offen offset:0 lds
    s_add_u32 s6, s6, s72
    buffer_load_dwordx4 v8, s[12:15], s6 offen offset:1024 lds
    s_add_u32 s6, s6, s72
    buffer_load_dwordx4 v9, s[12:15], s6 offen offset:2048 lds
    s_add_u32 s6, s6, s72
    buffer_load_dwordx4 v9, s[12:15], s6 offen offset:3072 lds
    s_waitcnt vmcnt(8)
    s_barrier
    s_add_u32 s4, s65, 7
    s_and_b32 s4, s4, 3
    s_or_b32 s4, s4, 4
    s_add_u32 m0, s74, 98304
    s_lshl_b32 s5, s4, 7
    buffer_load_dwordx4 v4, s[8:11], s5 offen offset:0 lds
    buffer_load_dwordx4 v5, s[8:11], s5 offen offset:1024 lds
    buffer_load_dwordx4 v6, s[8:11], s5 offen offset:2048 lds
    buffer_load_dwordx4 v7, s[8:11], s5 offen offset:3072 lds
    s_add_u32 m0, s74, 114688
    s_mul_i32 s6, s4, s73
    buffer_load_dwordx4 v8, s[12:15], s6 offen offset:0 lds
    s_add_u32 s6, s6, s72
    buffer_load_dwordx4 v8, s[12:15], s6 offen offset:1024 lds
    s_add_u32 s6, s6, s72
    buffer_load_dwordx4 v9, s[12:15], s6 offen offset:2048 lds
    s_add_u32 s6, s6, s72
    buffer_load_dwordx4 v9, s[12:15], s6 offen offset:3072 lds
    s_waitcnt vmcnt(8)
    s_barrier
    s_waitcnt vmcnt(0)
    s_barrier
    s_waitcnt lgkmcnt(0)
    s_barrier
    s_add_u32 s58, s58, 1
    s_lshr_b32 s4, s76, 3
    s_lshl_b32 s4, s4, 5
    s_add_u32 s4, s4, s61
    s_lshl_b32 s4, s4, 11
    s_add_u32 s4, s4, 10485760
    s_add_u32 s8, s56, s4
    s_addc_u32 s9, s57, 0
    s_mov_b32 s6, 1024
    s_lshl_b32 s70, s76, 16
    s_lshl_b32 s71, s77, 13
    s_add_u32 s70, s70, s71
    s_mov_b32 s71, 141312
    s_cmp_eq_u32 s68, 1
    s_cselect_b32 s6, 0, s6
    s_cselect_b32 s70, s88, s70
    s_cselect_b32 s71, 0, s71
    s_cmp_eq_u32 s68, 2
    s_cselect_b32 s6, 1160, s6
    s_cselect_b32 s70, s89, s70
    s_cselect_b32 s71, 0x10000, s71
    s_mov_b32 s5, 400000
    s_mov_b32 s59, s58
    s_mov_b64 s[12:13], 0
    s_mov_b32 m0, s71
    s_add_u32 s72, s70, 0x1000
    s_cmp_eq_u32 s62, 3
    s_cbranch_scc1 L_s1_nogate
    s_barrier
L_s1_nogate:
    s_cmp_eq_u32 s68, 3
    s_cbranch_scc0 L_s1_poll
    L_s1_poll7:
    s_load_dwordx4 s[36:39], s[8:9], 128 glc
    s_load_dwordx4 s[40:43], s[8:9], 256 glc
    s_load_dwordx4 s[44:47], s[8:9], 384 glc
    s_sub_u32 s5, s5, 1
    s_cbranch_scc1 L_p1_join
    s_mov_b64 s[6:7], 0
    s_waitcnt lgkmcnt(0)
    s_xor_b64 s[10:11], s[36:37], s[58:59]
    s_or_b64 s[6:7], s[6:7], s[10:11]
    s_xor_b64 s[10:11], s[38:39], s[58:59]
    s_or_b64 s[6:7], s[6:7], s[10:11]
    s_xor_b64 s[10:11], s[40:41], s[58:59]
    s_or_b64 s[6:7], s[6:7], s[10:11]
    s_xor_b64 s[10:11], s[42:43], s[58:59]
    s_or_b64 s[6:7], s[6:7], s[10:11]
    s_xor_b64 s[10:11], s[44:45], s[58:59]
    s_or_b64 s[6:7], s[6:7], s[10:11]
    s_xor_b64 s[10:11], s[46:47], s[58:59]
    s_or_b64 s[6:7], s[6:7], s[10:11]
    s_cbranch_scc1 L_s1_poll7
    s_branch L_p1_join
L_s1_poll:
    s_load_dwordx2 s[10:11], s[8:9], s6 glc
    s_sub_u32 s5, s5, 1
    s_cbranch_scc1 L_s1_pdone
    s_waitcnt lgkmcnt(0)
    s_cmp_eq_u64 s[10:11], s[58:59]
    s_cbranch_scc0 L_s1_poll
L_s1_pdone:
    buffer_load_dwordx4 v120, s[16:19], s70 offen offset:0 sc1 lds
    buffer_load_dwordx4 v120, s[16:19], s70 offen offset:1024 sc1 lds
    buffer_load_dwordx4 v120, s[16:19], s70 offen offset:2048 sc1 lds
    buffer_load_dwordx4 v120, s[16:19], s70 offen offset:3072 sc1 lds
    s_add_u32 m0, s71, 0x1000
    s_nop 0
    buffer_load_dwordx4 v120, s[16:19], s72 offen offset:0 sc1 lds
    buffer_load_dwordx4 v120, s[16:19], s72 offen offset:1024 sc1 lds
    buffer_load_dwordx4 v120, s[16:19], s72 offen offset:2048 sc1 lds
    buffer_load_dwordx4 v120, s[16:19], s72 offen offset:3072 sc1 lds
    s_waitcnt vmcnt(0)
    s_branch L_p1_join
L_p1_compute:
    v_mov_b32 v122, v0
    v_lshlrev_b32 v120, 4, v0
    v_mov_b32 v224, 2.0
    v_mov_b32 v225, 2.0
    s_mov_b32 s75, 0
    s_mov_b32 s92, 0
    s_and_b32 s4, s61, 7
    s_lshl_b32 s76, s60, 2
    s_and_b32 s5, s61, 3
    s_add_u32 s76, s76, s5
    s_lshr_b32 s77, s61, 2
    s_and_b32 s78, s3, 3
    s_lshr_b32 s79, s3, 2
    s_lshl_b32 s80, s60, 3
    s_add_u32 s80, s80, s4
    s_mov_b32 s81, s64
    s_and_b32 s68, s3, 1
    s_lshr_b32 s69, s3, 1
    v_and_b32 v1, 15, v0
    v_lshrrev_b32 v2, 4, v0
    v_lshrrev_b32 v3, 1, v1
    v_xor_b32 v3, v3, v2
    v_lshlrev_b32 v3, 4, v3
    v_lshl_add_u32 v3, v1, 7, v3
    s_lshl_b32 s4, s68, 13
    v_add_u32 v4, s4, v3
    v_xor_b32 v5, 64, v4
    v_bfe_u32 v10, v0, 2, 2
    v_lshl_add_u32 v11, v2, 3, v10
    v_lshlrev_b32 v11, 8, v11
    v_lshlrev_b32 v10, 1, v10
    v_and_b32 v12, 1, v2
    v_or_b32 v10, v10, v12
    s_lshl_b32 s4, s69, 2
    v_xor_b32 v10, s4, v10
    v_lshl_add_u32 v11, v10, 5, v11
    v_and_b32 v10, 3, v0
    v_lshl_add_u32 v11, v10, 3, v11
    v_add_u32 v6, 16384, v11
    v_xor_b32 v7, 32, v6
    v_xor_b32 v8, 64, v6
    v_xor_b32 v9, 96, v6
    v_mov_b64 v[128:129], 0
    v_mov_b64 v[130:131], 0
    v_mov_b64 v[132:133], 0
    v_mov_b64 v[134:135], 0
    v_mov_b64 v[136:137], 0
    v_mov_b64 v[138:139], 0
    v_mov_b64 v[140:141], 0
    v_mov_b64 v[142:143], 0
    v_mov_b64 v[144:145], 0
    v_mov_b64 v[146:147], 0
    v_mov_b64 v[148:149], 0
    v_mov_b64 v[150:151], 0
    v_mov_b64 v[152:153], 0
    v_mov_b64 v[154:155], 0
    v_mov_b64 v[156:157], 0
    v_mov_b64 v[158:159], 0
    v_mov_b64 v[160:161], 0
    v_mov_b64 v[162:163], 0
    v_mov_b64 v[164:165], 0
    v_mov_b64 v[166:167], 0
    v_mov_b64 v[168:169], 0
    v_mov_b64 v[170:171], 0
    v_mov_b64 v[172:173], 0
    v_mov_b64 v[174:175], 0
    v_mov_b64 v[176:177], 0
    v_mov_b64 v[178:179], 0
    v_mov_b64 v[180:181], 0
    v_mov_b64 v[182:183], 0
    v_mov_b64 v[184:185], 0
    v_mov_b64 v[186:187], 0
    v_mov_b64 v[188:189], 0
    v_mov_b64 v[190:191], 0
    s_lshl_b32 s4, s77, 3
    s_lshl_b32 s5, s78, 1
    s_add_u32 s4, s4, s5
    s_add_u32 s4, s4, s79
    s_lshl_b32 s4, s4, 15
    s_lshl_b32 s5, s76, 10
    s_add_u32 s4, s4, s5
    s_add_u32 s82, s4, 7340032
    s_waitcnt lgkmcnt(0)
    s_mov_b32 s16, s56
    s_mov_b32 s17, s57
    s_mov_b32 s18, 11534336
    s_mov_b32 s19, 0x20000
    s_mov_b32 s32, s50
    s_mov_b32 s33, s51
    s_mov_b32 s34, 524288
    s_mov_b32 s35, 0x20000
    s_add_u32 s4, s56, 10092544
    s_addc_u32 s5, s57, 0
    s_load_dword s58, s[4:5], 0
    s_cmp_eq_u32 s3, 1
    s_cbranch_scc0 L_p1_nowarm
    s_lshr_b32 s4, s76, 3
    s_lshl_b32 s4, s4, 5
    s_add_u32 s4, s4, s61
    s_lshl_b32 s4, s4, 11
    s_add_u32 s4, s4, 10485760
    v_lshlrev_b32 v1, 7, v0
    v_mov_b32 v2, 0
    s_mov_b64 exec, 0x3ff
    buffer_atomic_add v2, v1, s[16:19], s4 offen sc1
    s_mov_b64 exec, -1
L_p1_nowarm:
    s_mov_b32 s20, s52
    s_mov_b32 s21, s53
    s_mov_b32 s22, 4194304
    s_mov_b32 s23, 0x20000
    s_mov_b32 s24, s38
    s_mov_b32 s25, s39
    s_mov_b32 s26, 8388608
    s_mov_b32 s27, 0x20000
    s_mov_b32 s28, s40
    s_mov_b32 s29, s41
    s_mov_b32 s30, 8388608
    s_mov_b32 s31, 0x20000
    s_lshl_b32 s4, s79, 16
    v_add_u32 v117, s4, v120
    v_add_u32 v2, 4, v122
    v_and_b32 v2, 8, v2
    v_lshrrev_b32 v2, 1, v2
    v_and_b32 v1, 11, v122
    v_min_u32 v1, 1, v1
    v_add_u32 v2, v1, v2
    v_and_b32 v1, 16, v122
    v_cmp_ne_u32 vcc, 0, v1
    s_mov_b32 s48, 0xffff
    s_mov_b32 s49, 0xffff
    v_lshlrev_b32 v2, 4, v2
    v_add_u32 v2, 131072, v2
    v_cndmask_b32 v118, v117, v2, vcc
    v_mov_b32 v2, 0x2000
    v_cndmask_b32 v119, v2, 0, vcc
    v_mov_b32 v116, 0xdddddddd
    v_and_b32 v1, 31, v122
    s_and_b32 s4, s76, 15
    s_lshl_b32 s4, s4, 6
    s_lshr_b32 s83, s76, 4
    s_add_u32 s84, s4, s83
    v_lshl_add_u32 v1, v1, 1, s84
    v_lshlrev_b32 v1, 12, v1
    v_lshrrev_b32 v2, 5, v122
    v_lshl_add_u32 v1, v2, 4, v1
    s_lshl_b32 s4, s3, 7
    v_add_u32 v121, s4, v1
    s_lshl_b32 s85, s83, 18
    s_lshl_b32 s4, s77, 15
    s_add_u32 s85, s85, s4
    s_lshl_b32 s4, s3, 12
    s_add_u32 s85, s85, s4
    s_add_u32 s85, s85, 6291456
    s_add_u32 s86, s85, 0x80000
    s_lshl_b32 s87, s81, 3
    s_add_u32 s87, s87, s3
    s_lshl_b32 s87, s87, 14
    s_add_u32 s87, s87, 9437184
    s_lshl_b32 s88, s76, 17
    s_add_u32 s88, s88, 2097152
    s_lshl_b32 s4, s79, 16
    s_add_u32 s89, s88, s4
    s_lshl_b32 s91, s78, 11
    s_add_u32 s90, s89, s91
    s_add_u32 s5, s91, 141312
    v_add_u32 v123, s5, v120
    s_add_u32 s91, s91, s4
    s_lshl_b32 s4, s64, 6
    s_lshl_b32 s5, s62, 4
    s_add_u32 s4, s4, s5
    s_add_u32 s4, s4, s63
    s_lshl_b32 s4, s4, 4
    s_add_u32 s93, s4, 10027008
    s_lshr_b32 s4, s76, 3
    s_lshl_b32 s4, s4, 5
    s_add_u32 s4, s4, s61
    s_lshl_b32 s4, s4, 11
    s_add_u32 s55, s4, 10485760
    s_and_b32 s4, s63, 7
    s_lshl_b32 s5, s4, 7
    s_and_b32 s6, s63, 8
    s_add_u32 s5, s5, s6
    s_lshl_b32 s6, s62, 2
    s_add_u32 s5, s5, s6
    s_lshl_b32 s6, s64, 16
    s_add_u32 s5, s5, s6
    s_add_u32 s5, s5, 10485756
    s_cmp_ge_u32 s4, 4
    s_cselect_b32 s4, s62, 0
    s_sub_u32 s4, s4, 1
    s_cmp_lt_u32 s4, 2
    s_cselect_b32 s54, s5, 0
    s_cmp_eq_u32 s62, 3
    s_cbranch_scc1 L_p1_A
    s_cmp_eq_u32 s62, 2
    s_cselect_b32 s52, 1400897536, 1.0
    s_cselect_b32 s73, 1024, 0
    s_cselect_b32 s7, 12, 0
    s_add_u32 s73, s73, 2097152
    s_cmp_eq_u32 s62, 0
    s_cselect_b32 s52, 1052289595, s52
    s_cselect_b32 s71, 16, 17
    s_cselect_b32 s72, 10, 11
    s_cselect_b32 s73, 0, s73
    s_mov_b32 s53, s52
    s_lshl_b32 s4, s64, 3
    s_lshl_b32 s5, s69, 2
    s_add_u32 s4, s4, s5
    s_lshl_b32 s4, s4, s71
    s_lshl_b32 s5, s63, 2
    s_lshl_b32 s6, s68, 1
    s_add_u32 s5, s5, s6
    s_lshl_b32 s5, s5, s72
    s_add_u32 s73, s73, s4
    s_add_u32 s73, s73, s5
    s_lshl_b32 s74, 1, s71
    s_lshl_b32 s75, 1, s72
    v_lshrrev_b32 v1, 1, v0
    v_xor_b32 v1, v1, v0
    v_and_b32 v1, 4, v1
    v_mul_u32_u24 v1, 3, v1
    v_and_b32 v1, s7, v1
    v_xor_b32 v1, v1, v0
    v_lshlrev_b32 v12, 4, v1
    v_add_u32 v13, s75, v12
    s_mov_b32 s70, 3
    s_and_b32 s4, s63, 7
    s_cmp_ge_u32 s4, 4
    s_cselect_b32 s12, s62, 0
    s_mov_b32 s13, 0
    s_cmp_lg_u32 s12, 0
    s_cselect_b32 s4, 2.0, 0
    s_mov_b32 s75, s73
    v_mov_b32 v224, v12
    v_mov_b32 v225, v13
    v_or_b32 v12, s4, v12
    v_or_b32 v13, s4, v13
    s_setprio 1
    s_cmp_eq_u32 s62, 2
    s_cbranch_scc1 L_p1_N
    s_barrier
    ds_read_b128 v[32:35], v4 offset:0
    ds_read_b64_tr_b16 v[48:49], v6 offset:0
    ds_read_b64_tr_b16 v[50:51], v6 offset:1024
    ds_read_b128 v[36:39], v4 offset:2048
    ds_read_b64_tr_b16 v[52:53], v7 offset:0
    ds_read_b64_tr_b16 v[54:55], v7 offset:1024
    ds_read_b128 v[40:43], v4 offset:4096
    ds_read_b64_tr_b16 v[56:57], v8 offset:0
    ds_read_b64_tr_b16 v[58:59], v8 offset:1024
    ds_read_b128 v[44:47], v4 offset:6144
    ds_read_b64_tr_b16 v[60:61], v9 offset:0
    ds_read_b64_tr_b16 v[62:63], v9 offset:1024
    s_waitcnt lgkmcnt(0)
.p2align 3
L_p1_loopT:
    v_mfma_f32_16x16x32_bf16 v[128:131], v[48:51], v[32:35], v[128:131]
    ds_read_b128 v[64:67], v5 offset:0
    ds_read_b64_tr_b16 v[80:81], v6 offset:8192
    v_mfma_f32_16x16x32_bf16 v[144:147], v[48:51], v[36:39], v[144:147]
    ds_read_b64_tr_b16 v[82:83], v6 offset:9216
    ds_read_b128 v[68:71], v5 offset:2048
    v_mfma_f32_16x16x32_bf16 v[160:163], v[48:51], v[40:43], v[160:163]
    ds_read_b64_tr_b16 v[84:85], v7 offset:8192
    ds_read_b64_tr_b16 v[86:87], v7 offset:9216
    v_mfma_f32_16x16x32_bf16 v[176:179], v[48:51], v[44:47], v[176:179]
    ds_read_b128 v[72:75], v5 offset:4096
    ds_read_b64_tr_b16 v[88:89], v8 offset:8192
    v_mfma_f32_16x16x32_bf16 v[132:135], v[52:55], v[32:35], v[132:135]
    ds_read_b64_tr_b16 v[90:91], v8 offset:9216
    ds_read_b128 v[76:79], v5 offset:6144
    v_mfma_f32_16x16x32_bf16 v[148:151], v[52:55], v[36:39], v[148:151]
    ds_read_b64_tr_b16 v[92:93], v9 offset:8192
    ds_read_b64_tr_b16 v[94:95], v9 offset:9216
    v_mfma_f32_16x16x32_bf16 v[164:167], v[52:55], v[40:43], v[164:167]
    v_mfma_f32_16x16x32_bf16 v[180:183], v[52:55], v[44:47], v[180:183]
    v_mfma_f32_16x16x32_bf16 v[136:139], v[56:59], v[32:35], v[136:139]
    v_mfma_f32_16x16x32_bf16 v[152:155], v[56:59], v[36:39], v[152:155]
    v_mfma_f32_16x16x32_bf16 v[168:171], v[56:59], v[40:43], v[168:171]
    v_mfma_f32_16x16x32_bf16 v[184:187], v[56:59], v[44:47], v[184:187]
    v_mfma_f32_16x16x32_bf16 v[140:143], v[60:63], v[32:35], v[140:143]
    v_mfma_f32_16x16x32_bf16 v[156:159], v[60:63], v[36:39], v[156:159]
    v_mfma_f32_16x16x32_bf16 v[172:175], v[60:63], v[40:43], v[172:175]
    v_mfma_f32_16x16x32_bf16 v[188:191], v[60:63], v[44:47], v[188:191]
    s_waitcnt lgkmcnt(0)
    s_barrier
    v_mfma_f32_16x16x32_bf16 v[128:131], v[80:83], v[64:67], v[128:131]
    ds_read_b128 v[32:35], v4 offset:32768
    ds_read_b64_tr_b16 v[48:49], v6 offset:32768
    v_mfma_f32_16x16x32_bf16 v[144:147], v[80:83], v[68:71], v[144:147]
    ds_read_b64_tr_b16 v[50:51], v6 offset:33792
    ds_read_b128 v[36:39], v4 offset:34816
    v_mfma_f32_16x16x32_bf16 v[160:163], v[80:83], v[72:75], v[160:163]
    ds_read_b64_tr_b16 v[52:53], v7 offset:32768
    ds_read_b64_tr_b16 v[54:55], v7 offset:33792
    v_mfma_f32_16x16x32_bf16 v[176:179], v[80:83], v[76:79], v[176:179]
    ds_read_b128 v[40:43], v4 offset:36864
    ds_read_b64_tr_b16 v[56:57], v8 offset:32768
    v_mfma_f32_16x16x32_bf16 v[132:135], v[84:87], v[64:67], v[132:135]
    ds_read_b64_tr_b16 v[58:59], v8 offset:33792
    ds_read_b128 v[44:47], v4 offset:38912
    v_mfma_f32_16x16x32_bf16 v[148:151], v[84:87], v[68:71], v[148:151]
    ds_read_b64_tr_b16 v[60:61], v9 offset:32768
    ds_read_b64_tr_b16 v[62:63], v9 offset:33792
    v_mfma_f32_16x16x32_bf16 v[164:167], v[84:87], v[72:75], v[164:167]
    v_mfma_f32_16x16x32_bf16 v[180:183], v[84:87], v[76:79], v[180:183]
    s_sub_u32 s70, s70, 1
    v_mfma_f32_16x16x32_bf16 v[136:139], v[88:91], v[64:67], v[136:139]
    v_mfma_f32_16x16x32_bf16 v[152:155], v[88:91], v[68:71], v[152:155]
    v_mfma_f32_16x16x32_bf16 v[168:171], v[88:91], v[72:75], v[168:171]
    v_mfma_f32_16x16x32_bf16 v[184:187], v[88:91], v[76:79], v[184:187]
    v_mfma_f32_16x16x32_bf16 v[140:143], v[92:95], v[64:67], v[140:143]
    v_mfma_f32_16x16x32_bf16 v[156:159], v[92:95], v[68:71], v[156:159]
    v_mfma_f32_16x16x32_bf16 v[172:175], v[92:95], v[72:75], v[172:175]
    v_mfma_f32_16x16x32_bf16 v[188:191], v[92:95], v[76:79], v[188:191]
    s_waitcnt lgkmcnt(0)
    s_cbranch_scc1 L_p1_lastT
    v_mfma_f32_16x16x32_bf16 v[128:131], v[48:51], v[32:35], v[128:131]
    ds_read_b128 v[64:67], v5 offset:32768
    ds_read_b64_tr_b16 v[80:81], v6 offset:40960
    v_mfma_f32_16x16x32_bf16 v[144:147], v[48:51], v[36:39], v[144:147]
    ds_read_b64_tr_b16 v[82:83], v6 offset:41984
    ds_read_b128 v[68:71], v5 offset:34816
    v_mfma_f32_16x16x32_bf16 v[160:163], v[48:51], v[40:43], v[160:163]
    ds_read_b64_tr_b16 v[84:85], v7 offset:40960
    ds_read_b64_tr_b16 v[86:87], v7 offset:41984
    v_mfma_f32_16x16x32_bf16 v[176:179], v[48:51], v[44:47], v[176:179]
    ds_read_b128 v[72:75], v5 offset:36864
    ds_read_b64_tr_b16 v[88:89], v8 offset:40960
    v_mfma_f32_16x16x32_bf16 v[132:135], v[52:55], v[32:35], v[132:135]
    ds_read_b64_tr_b16 v[90:91], v8 offset:41984
    ds_read_b128 v[76:79], v5 offset:38912
    v_mfma_f32_16x16x32_bf16 v[148:151], v[52:55], v[36:39], v[148:151]
    ds_read_b64_tr_b16 v[92:93], v9 offset:40960
    ds_read_b64_tr_b16 v[94:95], v9 offset:41984
    v_mfma_f32_16x16x32_bf16 v[164:167], v[52:55], v[40:43], v[164:167]
    v_mfma_f32_16x16x32_bf16 v[180:183], v[52:55], v[44:47], v[180:183]
    v_xor_b32 v4, 0x10000, v4
    v_mfma_f32_16x16x32_bf16 v[136:139], v[56:59], v[32:35], v[136:139]
    v_xor_b32 v5, 0x10000, v5
    v_mfma_f32_16x16x32_bf16 v[152:155], v[56:59], v[36:39], v[152:155]
    v_xor_b32 v6, 0x10000, v6
    v_mfma_f32_16x16x32_bf16 v[168:171], v[56:59], v[40:43], v[168:171]
    v_xor_b32 v7, 0x10000, v7
    v_mfma_f32_16x16x32_bf16 v[184:187], v[56:59], v[44:47], v[184:187]
    v_xor_b32 v8, 0x10000, v8
    v_mfma_f32_16x16x32_bf16 v[140:143], v[60:63], v[32:35], v[140:143]
    v_xor_b32 v9, 0x10000, v9
    v_mfma_f32_16x16x32_bf16 v[156:159], v[60:63], v[36:39], v[156:159]
    v_mfma_f32_16x16x32_bf16 v[172:175], v[60:63], v[40:43], v[172:175]
    v_mfma_f32_16x16x32_bf16 v[188:191], v[60:63], v[44:47], v[188:191]
    s_waitcnt lgkmcnt(0)
    s_barrier
    v_mfma_f32_16x16x32_bf16 v[128:131], v[80:83], v[64:67], v[128:131]
    ds_read_b128 v[32:35], v4 offset:0
    ds_read_b64_tr_b16 v[48:49], v6 offset:0
    v_mfma_f32_16x16x32_bf16 v[144:147], v[80:83], v[68:71], v[144:147]
    ds_read_b64_tr_b16 v[50:51], v6 offset:1024
    ds_read_b128 v[36:39], v4 offset:2048
    v_mfma_f32_16x16x32_bf16 v[160:163], v[80:83], v[72:75], v[160:163]
    ds_read_b64_tr_b16 v[52:53], v7 offset:0
    ds_read_b64_tr_b16 v[54:55], v7 offset:1024
    v_mfma_f32_16x16x32_bf16 v[176:179], v[80:83], v[76:79], v[176:179]
    ds_read_b128 v[40:43], v4 offset:4096
    ds_read_b64_tr_b16 v[56:57], v8 offset:0
    v_mfma_f32_16x16x32_bf16 v[132:135], v[84:87], v[64:67], v[132:135]
    ds_read_b64_tr_b16 v[58:59], v8 offset:1024
    ds_read_b128 v[44:47], v4 offset:6144
    v_mfma_f32_16x16x32_bf16 v[148:151], v[84:87], v[68:71], v[148:151]
    ds_read_b64_tr_b16 v[60:61], v9 offset:0
    ds_read_b64_tr_b16 v[62:63], v9 offset:1024
    v_mfma_f32_16x16x32_bf16 v[164:167], v[84:87], v[72:75], v[164:167]
    v_mfma_f32_16x16x32_bf16 v[180:183], v[84:87], v[76:79], v[180:183]
    v_mfma_f32_16x16x32_bf16 v[136:139], v[88:91], v[64:67], v[136:139]
    v_mfma_f32_16x16x32_bf16 v[152:155], v[88:91], v[68:71], v[152:155]
    v_mfma_f32_16x16x32_bf16 v[168:171], v[88:91], v[72:75], v[168:171]
    v_mfma_f32_16x16x32_bf16 v[184:187], v[88:91], v[76:79], v[184:187]
    v_mfma_f32_16x16x32_bf16 v[140:143], v[92:95], v[64:67], v[140:143]
    v_mfma_f32_16x16x32_bf16 v[156:159], v[92:95], v[68:71], v[156:159]
    v_mfma_f32_16x16x32_bf16 v[172:175], v[92:95], v[72:75], v[172:175]
    v_mfma_f32_16x16x32_bf16 v[188:191], v[92:95], v[76:79], v[188:191]
    s_waitcnt lgkmcnt(0)
    s_branch L_p1_loopT
L_p1_lastT:
    v_mfma_f32_16x16x32_bf16 v[128:131], v[48:51], v[32:35], v[128:131]
    ds_read_b128 v[64:67], v5 offset:32768
    ds_read_b64_tr_b16 v[80:81], v6 offset:40960
    ds_read_b64_tr_b16 v[82:83], v6 offset:41984
    v_mfma_f32_16x16x32_bf16 v[144:147], v[48:51], v[36:39], v[144:147]
    ds_read_b128 v[68:71], v5 offset:34816
    ds_read_b64_tr_b16 v[84:85], v7 offset:40960
    ds_read_b64_tr_b16 v[86:87], v7 offset:41984
    v_mfma_f32_16x16x32_bf16 v[160:163], v[48:51], v[40:43], v[160:163]
    ds_read_b128 v[72:75], v5 offset:36864
    ds_read_b64_tr_b16 v[88:89], v8 offset:40960
    ds_read_b64_tr_b16 v[90:91], v8 offset:41984
    v_mfma_f32_16x16x32_bf16 v[176:179], v[48:51], v[44:47], v[176:179]
    ds_read_b128 v[76:79], v5 offset:38912
    ds_read_b64_tr_b16 v[92:93], v9 offset:40960
    ds_read_b64_tr_b16 v[94:95], v9 offset:41984
    v_mfma_f32_16x16x32_bf16 v[132:135], v[52:55], v[32:35], v[132:135]
    v_mfma_f32_16x16x32_bf16 v[148:151], v[52:55], v[36:39], v[148:151]
    v_mfma_f32_16x16x32_bf16 v[164:167], v[52:55], v[40:43], v[164:167]
    v_mfma_f32_16x16x32_bf16 v[180:183], v[52:55], v[44:47], v[180:183]
    s_waitcnt lgkmcnt(0)
    s_barrier
    v_mfma_f32_16x16x32_bf16 v[128:131], v[80:83], v[64:67], v[128:131]
    v_mfma_f32_16x16x32_bf16 v[144:147], v[80:83], v[68:71], v[144:147]
    v_mfma_f32_16x16x32_bf16 v[160:163], v[80:83], v[72:75], v[160:163]
    v_mfma_f32_16x16x32_bf16 v[176:179], v[80:83], v[76:79], v[176:179]
    v_mfma_f32_16x16x32_bf16 v[132:135], v[84:87], v[64:67], v[132:135]
    v_mfma_f32_16x16x32_bf16 v[148:151], v[84:87], v[68:71], v[148:151]
    s_nop 3
    v_mul_f32 v128, s52, v128
    v_mul_f32 v129, s52, v129
    v_mfma_f32_16x16x32_bf16 v[164:167], v[84:87], v[72:75], v[164:167]
    v_mul_f32 v130, s52, v130
    v_mul_f32 v131, s52, v131
    v_mfma_f32_16x16x32_bf16 v[180:183], v[84:87], v[76:79], v[180:183]
    v_mul_f32 v144, s52, v144
    v_mul_f32 v145, s52, v145
    v_mfma_f32_16x16x32_bf16 v[136:139], v[56:59], v[32:35], v[136:139]
    v_mul_f32 v146, s52, v146
    v_mul_f32 v147, s52, v147
    v_mfma_f32_16x16x32_bf16 v[152:155], v[56:59], v[36:39], v[152:155]
    v_cvt_pk_bf16_f32 v192, v128, v129
    v_cvt_pk_bf16_f32 v194, v144, v145
    v_mfma_f32_16x16x32_bf16 v[168:171], v[56:59], v[40:43], v[168:171]
    v_cvt_pk_bf16_f32 v193, v130, v131
    v_cvt_pk_bf16_f32 v195, v146, v147
    v_mfma_f32_16x16x32_bf16 v[184:187], v[56:59], v[44:47], v[184:187]
    v_permlane16_swap_b32 v192, v194
    s_nop 0
    v_permlane16_swap_b32 v193, v195
    v_mfma_f32_16x16x32_bf16 v[136:139], v[88:91], v[64:67], v[136:139]
    buffer_store_dwordx4 v[192:195], v12, s[16:19], s73 offen sc1
    v_mul_f32 v160, s52, v160
    v_mfma_f32_16x16x32_bf16 v[152:155], v[88:91], v[68:71], v[152:155]
    v_mul_f32 v161, s52, v161
    v_mul_f32 v162, s52, v162
    v_mfma_f32_16x16x32_bf16 v[168:171], v[88:91], v[72:75], v[168:171]
    v_mul_f32 v163, s52, v163
    v_mul_f32 v176, s52, v176
    v_mfma_f32_16x16x32_bf16 v[184:187], v[88:91], v[76:79], v[184:187]
    v_mul_f32 v177, s52, v177
    v_mul_f32 v178, s52, v178
    v_mfma_f32_16x16x32_bf16 v[140:143], v[60:63], v[32:35], v[140:143]
    v_mul_f32 v179, s52, v179
    v_cvt_pk_bf16_f32 v196, v160, v161
    v_mfma_f32_16x16x32_bf16 v[156:159], v[60:63], v[36:39], v[156:159]
    v_cvt_pk_bf16_f32 v198, v176, v177
    v_cvt_pk_bf16_f32 v197, v162, v163
    v_mfma_f32_16x16x32_bf16 v[172:175], v[60:63], v[40:43], v[172:175]
    v_cvt_pk_bf16_f32 v199, v178, v179
    v_permlane16_swap_b32 v196, v198
    v_mfma_f32_16x16x32_bf16 v[188:191], v[60:63], v[44:47], v[188:191]
    s_nop 0
    v_permlane16_swap_b32 v197, v199
    buffer_store_dwordx4 v[196:199], v13, s[16:19], s73 offen sc1
    s_add_u32 s73, s73, s74
    v_mfma_f32_16x16x32_bf16 v[140:143], v[92:95], v[64:67], v[140:143]
    v_mul_f32 v132, s52, v132
    v_mul_f32 v133, s52, v133
    v_mfma_f32_16x16x32_bf16 v[156:159], v[92:95], v[68:71], v[156:159]
    v_mul_f32 v134, s52, v134
    v_mul_f32 v135, s52, v135
    v_mfma_f32_16x16x32_bf16 v[172:175], v[92:95], v[72:75], v[172:175]
    v_mul_f32 v148, s52, v148
    v_mul_f32 v149, s52, v149
    v_mfma_f32_16x16x32_bf16 v[188:191], v[92:95], v[76:79], v[188:191]
    v_mul_f32 v150, s52, v150
    v_mul_f32 v151, s52, v151
    v_cvt_pk_bf16_f32 v200, v132, v133
    v_cvt_pk_bf16_f32 v202, v148, v149
    v_cvt_pk_bf16_f32 v201, v134, v135
    v_cvt_pk_bf16_f32 v203, v150, v151
    v_permlane16_swap_b32 v200, v202
    s_nop 0
    v_permlane16_swap_b32 v201, v203
    buffer_store_dwordx4 v[200:203], v12, s[16:19], s73 offen sc1
    v_mul_f32 v164, s52, v164
    v_mul_f32 v165, s52, v165
    v_mul_f32 v166, s52, v166
    v_mul_f32 v167, s52, v167
    v_mul_f32 v180, s52, v180
    v_mul_f32 v181, s52, v181
    v_mul_f32 v182, s52, v182
    v_mul_f32 v183, s52, v183
    v_cvt_pk_bf16_f32 v204, v164, v165
    v_cvt_pk_bf16_f32 v206, v180, v181
    v_cvt_pk_bf16_f32 v205, v166, v167
    v_cvt_pk_bf16_f32 v207, v182, v183
    v_permlane16_swap_b32 v204, v206
    s_nop 0
    v_permlane16_swap_b32 v205, v207
    buffer_store_dwordx4 v[204:207], v13, s[16:19], s73 offen sc1
    s_add_u32 s73, s73, s74
    v_mul_f32 v136, s52, v136
    v_mul_f32 v137, s52, v137
    v_mul_f32 v138, s52, v138
    v_mul_f32 v139, s52, v139
    v_mul_f32 v152, s52, v152
    v_mul_f32 v153, s52, v153
    v_mul_f32 v154, s52, v154
    v_mul_f32 v155, s52, v155
    v_cvt_pk_bf16_f32 v208, v136, v137
    v_cvt_pk_bf16_f32 v210, v152, v153
    v_cvt_pk_bf16_f32 v209, v138, v139
    v_cvt_pk_bf16_f32 v211, v154, v155
    v_permlane16_swap_b32 v208, v210
    s_nop 0
    v_permlane16_swap_b32 v209, v211
    buffer_store_dwordx4 v[208:211], v12, s[16:19], s73 offen sc1
    v_mul_f32 v168, s52, v168
    v_mul_f32 v169, s52, v169
    v_mul_f32 v170, s52, v170
    v_mul_f32 v171, s52, v171
    v_mul_f32 v184, s52, v184
    v_mul_f32 v185, s52, v185
    v_mul_f32 v186, s52, v186
    v_mul_f32 v187, s52, v187
    v_cvt_pk_bf16_f32 v212, v168, v169
    v_cvt_pk_bf16_f32 v214, v184, v185
    v_cvt_pk_bf16_f32 v213, v170, v171
    v_cvt_pk_bf16_f32 v215, v186, v187
    v_permlane16_swap_b32 v212, v214
    s_nop 0
    v_permlane16_swap_b32 v213, v215
    buffer_store_dwordx4 v[212:215], v13, s[16:19], s73 offen sc1
    s_add_u32 s73, s73, s74
    v_pk_mul_f32 v[140:141], v[140:141], s[52:53]
    v_pk_mul_f32 v[142:143], v[142:143], s[52:53]
    v_pk_mul_f32 v[156:157], v[156:157], s[52:53]
    v_pk_mul_f32 v[158:159], v[158:159], s[52:53]
    v_cvt_pk_bf16_f32 v216, v140, v141
    v_cvt_pk_bf16_f32 v218, v156, v157
    v_cvt_pk_bf16_f32 v217, v142, v143
    v_cvt_pk_bf16_f32 v219, v158, v159
    v_permlane16_swap_b32 v216, v218
    s_nop 0
    v_permlane16_swap_b32 v217, v219
    buffer_store_dwordx4 v[216:219], v12, s[16:19], s73 offen sc1
    v_pk_mul_f32 v[172:173], v[172:173], s[52:53]
    v_pk_mul_f32 v[174:175], v[174:175], s[52:53]
    v_pk_mul_f32 v[188:189], v[188:189], s[52:53]
    v_pk_mul_f32 v[190:191], v[190:191], s[52:53]
    v_cvt_pk_bf16_f32 v220, v172, v173
    v_cvt_pk_bf16_f32 v222, v188, v189
    v_cvt_pk_bf16_f32 v221, v174, v175
    v_cvt_pk_bf16_f32 v223, v190, v191
    v_permlane16_swap_b32 v220, v222
    s_nop 0
    v_permlane16_swap_b32 v221, v223
    buffer_store_dwordx4 v[220:223], v13, s[16:19], s73 offen sc1
    s_barrier
    s_branch L_p1_cdone
L_p1_N:
    s_barrier
    ds_read_b128 v[32:35], v4 offset:0
    ds_read_b64_tr_b16 v[48:49], v6 offset:0
    ds_read_b64_tr_b16 v[50:51], v6 offset:1024
    ds_read_b128 v[36:39], v4 offset:2048
    ds_read_b64_tr_b16 v[52:53], v7 offset:0
    ds_read_b64_tr_b16 v[54:55], v7 offset:1024
    ds_read_b128 v[40:43], v4 offset:4096
    ds_read_b64_tr_b16 v[56:57], v8 offset:0
    ds_read_b64_tr_b16 v[58:59], v8 offset:1024
    ds_read_b128 v[44:47], v4 offset:6144
    ds_read_b64_tr_b16 v[60:61], v9 offset:0
    ds_read_b64_tr_b16 v[62:63], v9 offset:1024
    s_waitcnt lgkmcnt(0)
.p2align 3
L_p1_loopN:
    v_mfma_f32_16x16x32_bf16 v[128:131], v[32:35], v[48:51], v[128:131]
    ds_read_b128 v[64:67], v5 offset:0
    ds_read_b64_tr_b16 v[80:81], v6 offset:8192
    v_mfma_f32_16x16x32_bf16 v[144:147], v[36:39], v[48:51], v[144:147]
    ds_read_b64_tr_b16 v[82:83], v6 offset:9216
    ds_read_b128 v[68:71], v5 offset:2048
    v_mfma_f32_16x16x32_bf16 v[160:163], v[40:43], v[48:51], v[160:163]
    ds_read_b64_tr_b16 v[84:85], v7 offset:8192
    ds_read_b64_tr_b16 v[86:87], v7 offset:9216
    v_mfma_f32_16x16x32_bf16 v[176:179], v[44:47], v[48:51], v[176:179]
    ds_read_b128 v[72:75], v5 offset:4096
    ds_read_b64_tr_b16 v[88:89], v8 offset:8192
    v_mfma_f32_16x16x32_bf16 v[132:135], v[32:35], v[52:55], v[132:135]
    ds_read_b64_tr_b16 v[90:91], v8 offset:9216
    ds_read_b128 v[76:79], v5 offset:6144
    v_mfma_f32_16x16x32_bf16 v[148:151], v[36:39], v[52:55], v[148:151]
    ds_read_b64_tr_b16 v[92:93], v9 offset:8192
    ds_read_b64_tr_b16 v[94:95], v9 offset:9216
    v_mfma_f32_16x16x32_bf16 v[164:167], v[40:43], v[52:55], v[164:167]
    v_mfma_f32_16x16x32_bf16 v[180:183], v[44:47], v[52:55], v[180:183]
    v_mfma_f32_16x16x32_bf16 v[136:139], v[32:35], v[56:59], v[136:139]
    v_mfma_f32_16x16x32_bf16 v[152:155], v[36:39], v[56:59], v[152:155]
    v_mfma_f32_16x16x32_bf16 v[168:171], v[40:43], v[56:59], v[168:171]
    v_mfma_f32_16x16x32_bf16 v[184:187], v[44:47], v[56:59], v[184:187]
    v_mfma_f32_16x16x32_bf16 v[140:143], v[32:35], v[60:63], v[140:143]
    v_mfma_f32_16x16x32_bf16 v[156:159], v[36:39], v[60:63], v[156:159]
    v_mfma_f32_16x16x32_bf16 v[172:175], v[40:43], v[60:63], v[172:175]
    v_mfma_f32_16x16x32_bf16 v[188:191], v[44:47], v[60:63], v[188:191]
    s_waitcnt lgkmcnt(0)
    s_barrier
    v_mfma_f32_16x16x32_bf16 v[128:131], v[64:67], v[80:83], v[128:131]
    ds_read_b128 v[32:35], v4 offset:32768
    ds_read_b64_tr_b16 v[48:49], v6 offset:32768
    v_mfma_f32_16x16x32_bf16 v[144:147], v[68:71], v[80:83], v[144:147]
    ds_read_b64_tr_b16 v[50:51], v6 offset:33792
    ds_read_b128 v[36:39], v4 offset:34816
    v_mfma_f32_16x16x32_bf16 v[160:163], v[72:75], v[80:83], v[160:163]
    ds_read_b64_tr_b16 v[52:53], v7 offset:32768
    ds_read_b64_tr_b16 v[54:55], v7 offset:33792
    v_mfma_f32_16x16x32_bf16 v[176:179], v[76:79], v[80:83], v[176:179]
    ds_read_b128 v[40:43], v4 offset:36864
    ds_read_b64_tr_b16 v[56:57], v8 offset:32768
    v_mfma_f32_16x16x32_bf16 v[132:135], v[64:67], v[84:87], v[132:135]
    ds_read_b64_tr_b16 v[58:59], v8 offset:33792
    ds_read_b128 v[44:47], v4 offset:38912
    v_mfma_f32_16x16x32_bf16 v[148:151], v[68:71], v[84:87], v[148:151]
    ds_read_b64_tr_b16 v[60:61], v9 offset:32768
    ds_read_b64_tr_b16 v[62:63], v9 offset:33792
    v_mfma_f32_16x16x32_bf16 v[164:167], v[72:75], v[84:87], v[164:167]
    v_mfma_f32_16x16x32_bf16 v[180:183], v[76:79], v[84:87], v[180:183]
    s_sub_u32 s70, s70, 1
    v_mfma_f32_16x16x32_bf16 v[136:139], v[64:67], v[88:91], v[136:139]
    v_mfma_f32_16x16x32_bf16 v[152:155], v[68:71], v[88:91], v[152:155]
    v_mfma_f32_16x16x32_bf16 v[168:171], v[72:75], v[88:91], v[168:171]
    v_mfma_f32_16x16x32_bf16 v[184:187], v[76:79], v[88:91], v[184:187]
    v_mfma_f32_16x16x32_bf16 v[140:143], v[64:67], v[92:95], v[140:143]
    v_mfma_f32_16x16x32_bf16 v[156:159], v[68:71], v[92:95], v[156:159]
    v_mfma_f32_16x16x32_bf16 v[172:175], v[72:75], v[92:95], v[172:175]
    v_mfma_f32_16x16x32_bf16 v[188:191], v[76:79], v[92:95], v[188:191]
    s_waitcnt lgkmcnt(0)
    s_cbranch_scc1 L_p1_lastN
    v_mfma_f32_16x16x32_bf16 v[128:131], v[32:35], v[48:51], v[128:131]
    ds_read_b128 v[64:67], v5 offset:32768
    ds_read_b64_tr_b16 v[80:81], v6 offset:40960
    v_mfma_f32_16x16x32_bf16 v[144:147], v[36:39], v[48:51], v[144:147]
    ds_read_b64_tr_b16 v[82:83], v6 offset:41984
    ds_read_b128 v[68:71], v5 offset:34816
    v_mfma_f32_16x16x32_bf16 v[160:163], v[40:43], v[48:51], v[160:163]
    ds_read_b64_tr_b16 v[84:85], v7 offset:40960
    ds_read_b64_tr_b16 v[86:87], v7 offset:41984
    v_mfma_f32_16x16x32_bf16 v[176:179], v[44:47], v[48:51], v[176:179]
    ds_read_b128 v[72:75], v5 offset:36864
    ds_read_b64_tr_b16 v[88:89], v8 offset:40960
    v_mfma_f32_16x16x32_bf16 v[132:135], v[32:35], v[52:55], v[132:135]
    ds_read_b64_tr_b16 v[90:91], v8 offset:41984
    ds_read_b128 v[76:79], v5 offset:38912
    v_mfma_f32_16x16x32_bf16 v[148:151], v[36:39], v[52:55], v[148:151]
    ds_read_b64_tr_b16 v[92:93], v9 offset:40960
    ds_read_b64_tr_b16 v[94:95], v9 offset:41984
    v_mfma_f32_16x16x32_bf16 v[164:167], v[40:43], v[52:55], v[164:167]
    v_mfma_f32_16x16x32_bf16 v[180:183], v[44:47], v[52:55], v[180:183]
    v_xor_b32 v4, 0x10000, v4
    v_mfma_f32_16x16x32_bf16 v[136:139], v[32:35], v[56:59], v[136:139]
    v_xor_b32 v5, 0x10000, v5
    v_mfma_f32_16x16x32_bf16 v[152:155], v[36:39], v[56:59], v[152:155]
    v_xor_b32 v6, 0x10000, v6
    v_mfma_f32_16x16x32_bf16 v[168:171], v[40:43], v[56:59], v[168:171]
    v_xor_b32 v7, 0x10000, v7
    v_mfma_f32_16x16x32_bf16 v[184:187], v[44:47], v[56:59], v[184:187]
    v_xor_b32 v8, 0x10000, v8
    v_mfma_f32_16x16x32_bf16 v[140:143], v[32:35], v[60:63], v[140:143]
    v_xor_b32 v9, 0x10000, v9
    v_mfma_f32_16x16x32_bf16 v[156:159], v[36:39], v[60:63], v[156:159]
    v_mfma_f32_16x16x32_bf16 v[172:175], v[40:43], v[60:63], v[172:175]
    v_mfma_f32_16x16x32_bf16 v[188:191], v[44:47], v[60:63], v[188:191]
    s_waitcnt lgkmcnt(0)
    s_barrier
    v_mfma_f32_16x16x32_bf16 v[128:131], v[64:67], v[80:83], v[128:131]
    ds_read_b128 v[32:35], v4 offset:0
    ds_read_b64_tr_b16 v[48:49], v6 offset:0
    v_mfma_f32_16x16x32_bf16 v[144:147], v[68:71], v[80:83], v[144:147]
    ds_read_b64_tr_b16 v[50:51], v6 offset:1024
    ds_read_b128 v[36:39], v4 offset:2048
    v_mfma_f32_16x16x32_bf16 v[160:163], v[72:75], v[80:83], v[160:163]
    ds_read_b64_tr_b16 v[52:53], v7 offset:0
    ds_read_b64_tr_b16 v[54:55], v7 offset:1024
    v_mfma_f32_16x16x32_bf16 v[176:179], v[76:79], v[80:83], v[176:179]
    ds_read_b128 v[40:43], v4 offset:4096
    ds_read_b64_tr_b16 v[56:57], v8 offset:0
    v_mfma_f32_16x16x32_bf16 v[132:135], v[64:67], v[84:87], v[132:135]
    ds_read_b64_tr_b16 v[58:59], v8 offset:1024
    ds_read_b128 v[44:47], v4 offset:6144
    v_mfma_f32_16x16x32_bf16 v[148:151], v[68:71], v[84:87], v[148:151]
    ds_read_b64_tr_b16 v[60:61], v9 offset:0
    ds_read_b64_tr_b16 v[62:63], v9 offset:1024
    v_mfma_f32_16x16x32_bf16 v[164:167], v[72:75], v[84:87], v[164:167]
    v_mfma_f32_16x16x32_bf16 v[180:183], v[76:79], v[84:87], v[180:183]
    v_mfma_f32_16x16x32_bf16 v[136:139], v[64:67], v[88:91], v[136:139]
    v_mfma_f32_16x16x32_bf16 v[152:155], v[68:71], v[88:91], v[152:155]
    v_mfma_f32_16x16x32_bf16 v[168:171], v[72:75], v[88:91], v[168:171]
    v_mfma_f32_16x16x32_bf16 v[184:187], v[76:79], v[88:91], v[184:187]
    v_mfma_f32_16x16x32_bf16 v[140:143], v[64:67], v[92:95], v[140:143]
    v_mfma_f32_16x16x32_bf16 v[156:159], v[68:71], v[92:95], v[156:159]
    v_mfma_f32_16x16x32_bf16 v[172:175], v[72:75], v[92:95], v[172:175]
    v_mfma_f32_16x16x32_bf16 v[188:191], v[76:79], v[92:95], v[188:191]
    s_waitcnt lgkmcnt(0)
    s_branch L_p1_loopN
L_p1_lastN:
    v_mfma_f32_16x16x32_bf16 v[128:131], v[32:35], v[48:51], v[128:131]
    ds_read_b128 v[64:67], v5 offset:32768
    ds_read_b64_tr_b16 v[80:81], v6 offset:40960
    ds_read_b64_tr_b16 v[82:83], v6 offset:41984
    v_mfma_f32_16x16x32_bf16 v[144:147], v[36:39], v[48:51], v[144:147]
    ds_read_b128 v[68:71], v5 offset:34816
    ds_read_b64_tr_b16 v[84:85], v7 offset:40960
    ds_read_b64_tr_b16 v[86:87], v7 offset:41984
    v_mfma_f32_16x16x32_bf16 v[160:163], v[40:43], v[48:51], v[160:163]
    ds_read_b128 v[72:75], v5 offset:36864
    ds_read_b64_tr_b16 v[88:89], v8 offset:40960
    ds_read_b64_tr_b16 v[90:91], v8 offset:41984
    v_mfma_f32_16x16x32_bf16 v[176:179], v[44:47], v[48:51], v[176:179]
    ds_read_b128 v[76:79], v5 offset:38912
    ds_read_b64_tr_b16 v[92:93], v9 offset:40960
    ds_read_b64_tr_b16 v[94:95], v9 offset:41984
    v_mfma_f32_16x16x32_bf16 v[132:135], v[32:35], v[52:55], v[132:135]
    v_mfma_f32_16x16x32_bf16 v[148:151], v[36:39], v[52:55], v[148:151]
    v_mfma_f32_16x16x32_bf16 v[164:167], v[40:43], v[52:55], v[164:167]
    v_mfma_f32_16x16x32_bf16 v[180:183], v[44:47], v[52:55], v[180:183]
    s_waitcnt lgkmcnt(0)
    s_barrier
    v_mfma_f32_16x16x32_bf16 v[128:131], v[64:67], v[80:83], v[128:131]
    v_mfma_f32_16x16x32_bf16 v[144:147], v[68:71], v[80:83], v[144:147]
    v_mfma_f32_16x16x32_bf16 v[160:163], v[72:75], v[80:83], v[160:163]
    v_mfma_f32_16x16x32_bf16 v[176:179], v[76:79], v[80:83], v[176:179]
    v_mfma_f32_16x16x32_bf16 v[132:135], v[64:67], v[84:87], v[132:135]
    v_mfma_f32_16x16x32_bf16 v[148:151], v[68:71], v[84:87], v[148:151]
    s_nop 3
    v_mul_f32 v128, s52, v128
    v_mul_f32 v129, s52, v129
    v_mfma_f32_16x16x32_bf16 v[164:167], v[72:75], v[84:87], v[164:167]
    v_mul_f32 v130, s52, v130
    v_mul_f32 v131, s52, v131
    v_mfma_f32_16x16x32_bf16 v[180:183], v[76:79], v[84:87], v[180:183]
    v_mul_f32 v144, s52, v144
    v_mul_f32 v145, s52, v145
    v_mfma_f32_16x16x32_bf16 v[136:139], v[32:35], v[56:59], v[136:139]
    v_mul_f32 v146, s52, v146
    v_mul_f32 v147, s52, v147
    v_mfma_f32_16x16x32_bf16 v[152:155], v[36:39], v[56:59], v[152:155]
    v_cvt_pk_bf16_f32 v192, v128, v129
    v_cvt_pk_bf16_f32 v194, v144, v145
    v_mfma_f32_16x16x32_bf16 v[168:171], v[40:43], v[56:59], v[168:171]
    v_cvt_pk_bf16_f32 v193, v130, v131
    v_cvt_pk_bf16_f32 v195, v146, v147
    v_mfma_f32_16x16x32_bf16 v[184:187], v[44:47], v[56:59], v[184:187]
    v_permlane16_swap_b32 v192, v194
    s_nop 0
    v_permlane16_swap_b32 v193, v195
    v_mfma_f32_16x16x32_bf16 v[136:139], v[64:67], v[88:91], v[136:139]
    buffer_store_dwordx4 v[192:195], v12, s[16:19], s73 offen sc1
    v_mul_f32 v160, s52, v160
    v_mfma_f32_16x16x32_bf16 v[152:155], v[68:71], v[88:91], v[152:155]
    v_mul_f32 v161, s52, v161
    v_mul_f32 v162, s52, v162
    v_mfma_f32_16x16x32_bf16 v[168:171], v[72:75], v[88:91], v[168:171]
    v_mul_f32 v163, s52, v163
    v_mul_f32 v176, s52, v176
    v_mfma_f32_16x16x32_bf16 v[184:187], v[76:79], v[88:91], v[184:187]
    v_mul_f32 v177, s52, v177
    v_mul_f32 v178, s52, v178
    v_mfma_f32_16x16x32_bf16 v[140:143], v[32:35], v[60:63], v[140:143]
    v_mul_f32 v179, s52, v179
    v_cvt_pk_bf16_f32 v196, v160, v161
    v_mfma_f32_16x16x32_bf16 v[156:159], v[36:39], v[60:63], v[156:159]
    v_cvt_pk_bf16_f32 v198, v176, v177
    v_cvt_pk_bf16_f32 v197, v162, v163
    v_mfma_f32_16x16x32_bf16 v[172:175], v[40:43], v[60:63], v[172:175]
    v_cvt_pk_bf16_f32 v199, v178, v179
    v_permlane16_swap_b32 v196, v198
    v_mfma_f32_16x16x32_bf16 v[188:191], v[44:47], v[60:63], v[188:191]
    s_nop 0
    v_permlane16_swap_b32 v197, v199
    buffer_store_dwordx4 v[196:199], v13, s[16:19], s73 offen sc1
    s_add_u32 s73, s73, s74
    v_mfma_f32_16x16x32_bf16 v[140:143], v[64:67], v[92:95], v[140:143]
    v_mul_f32 v132, s52, v132
    v_mul_f32 v133, s52, v133
    v_mfma_f32_16x16x32_bf16 v[156:159], v[68:71], v[92:95], v[156:159]
    v_mul_f32 v134, s52, v134
    v_mul_f32 v135, s52, v135
    v_mfma_f32_16x16x32_bf16 v[172:175], v[72:75], v[92:95], v[172:175]
    v_mul_f32 v148, s52, v148
    v_mul_f32 v149, s52, v149
    v_mfma_f32_16x16x32_bf16 v[188:191], v[76:79], v[92:95], v[188:191]
    v_mul_f32 v150, s52, v150
    v_mul_f32 v151, s52, v151
    v_cvt_pk_bf16_f32 v200, v132, v133
    v_cvt_pk_bf16_f32 v202, v148, v149
    v_cvt_pk_bf16_f32 v201, v134, v135
    v_cvt_pk_bf16_f32 v203, v150, v151
    v_permlane16_swap_b32 v200, v202
    s_nop 0
    v_permlane16_swap_b32 v201, v203
    buffer_store_dwordx4 v[200:203], v12, s[16:19], s73 offen sc1
    v_mul_f32 v164, s52, v164
    v_mul_f32 v165, s52, v165
    v_mul_f32 v166, s52, v166
    v_mul_f32 v167, s52, v167
    v_mul_f32 v180, s52, v180
    v_mul_f32 v181, s52, v181
    v_mul_f32 v182, s52, v182
    v_mul_f32 v183, s52, v183
    v_cvt_pk_bf16_f32 v204, v164, v165
    v_cvt_pk_bf16_f32 v206, v180, v181
    v_cvt_pk_bf16_f32 v205, v166, v167
    v_cvt_pk_bf16_f32 v207, v182, v183
    v_permlane16_swap_b32 v204, v206
    s_nop 0
    v_permlane16_swap_b32 v205, v207
    buffer_store_dwordx4 v[204:207], v13, s[16:19], s73 offen sc1
    s_add_u32 s73, s73, s74
    v_mul_f32 v136, s52, v136
    v_mul_f32 v137, s52, v137
    v_mul_f32 v138, s52, v138
    v_mul_f32 v139, s52, v139
    v_mul_f32 v152, s52, v152
    v_mul_f32 v153, s52, v153
    v_mul_f32 v154, s52, v154
    v_mul_f32 v155, s52, v155
    v_cvt_pk_bf16_f32 v208, v136, v137
    v_cvt_pk_bf16_f32 v210, v152, v153
    v_cvt_pk_bf16_f32 v209, v138, v139
    v_cvt_pk_bf16_f32 v211, v154, v155
    v_permlane16_swap_b32 v208, v210
    s_nop 0
    v_permlane16_swap_b32 v209, v211
    buffer_store_dwordx4 v[208:211], v12, s[16:19], s73 offen sc1
    v_mul_f32 v168, s52, v168
    v_mul_f32 v169, s52, v169
    v_mul_f32 v170, s52, v170
    v_mul_f32 v171, s52, v171
    v_mul_f32 v184, s52, v184
    v_mul_f32 v185, s52, v185
    v_mul_f32 v186, s52, v186
    v_mul_f32 v187, s52, v187
    v_cvt_pk_bf16_f32 v212, v168, v169
    v_cvt_pk_bf16_f32 v214, v184, v185
    v_cvt_pk_bf16_f32 v213, v170, v171
    v_cvt_pk_bf16_f32 v215, v186, v187
    v_permlane16_swap_b32 v212, v214
    s_nop 0
    v_permlane16_swap_b32 v213, v215
    buffer_store_dwordx4 v[212:215], v13, s[16:19], s73 offen sc1
    s_add_u32 s73, s73, s74
    v_pk_mul_f32 v[140:141], v[140:141], s[52:53]
    v_pk_mul_f32 v[142:143], v[142:143], s[52:53]
    v_pk_mul_f32 v[156:157], v[156:157], s[52:53]
    v_pk_mul_f32 v[158:159], v[158:159], s[52:53]
    v_cvt_pk_bf16_f32 v216, v140, v141
    v_cvt_pk_bf16_f32 v218, v156, v157
    v_cvt_pk_bf16_f32 v217, v142, v143
    v_cvt_pk_bf16_f32 v219, v158, v159
    v_permlane16_swap_b32 v216, v218
    s_nop 0
    v_permlane16_swap_b32 v217, v219
    buffer_store_dwordx4 v[216:219], v12, s[16:19], s73 offen sc1
    v_pk_mul_f32 v[172:173], v[172:173], s[52:53]
    v_pk_mul_f32 v[174:175], v[174:175], s[52:53]
    v_pk_mul_f32 v[188:189], v[188:189], s[52:53]
    v_pk_mul_f32 v[190:191], v[190:191], s[52:53]
    v_cvt_pk_bf16_f32 v220, v172, v173
    v_cvt_pk_bf16_f32 v222, v188, v189
    v_cvt_pk_bf16_f32 v221, v174, v175
    v_cvt_pk_bf16_f32 v223, v190, v191
    v_permlane16_swap_b32 v220, v222
    s_nop 0
    v_permlane16_swap_b32 v221, v223
    buffer_store_dwordx4 v[220:223], v13, s[16:19], s73 offen sc1
    s_barrier
    s_branch L_p1_cdone
L_p1_A:
    v_lshrrev_b32 v1, 2, v0
    v_and_b32 v2, 3, v0
    v_lshlrev_b32 v3, 4, v2
    v_lshl_add_u32 v15, v1, 10, v3
    v_lshrrev_b32 v3, 4, v0
    v_bfe_u32 v10, v0, 2, 2
    v_lshl_add_u32 v3, v3, 3, v10
    v_lshlrev_b32 v3, 6, v3
    v_lshl_add_u32 v3, v2, 3, v3
    s_lshl_b32 s71, s3, 11
    s_add_u32 s71, s71, 149504
    v_add_u32 v20, s71, v3
    s_lshl_b32 s6, s64, 2
    s_add_u32 s6, s6, s3
    s_lshl_b32 s4, s63, 15
    s_lshl_b32 s5, s6, 6
    s_add_u32 s72, s4, s5
    s_mov_b32 m0, s71
    s_add_u32 s73, s72, 0x3c00
    buffer_load_dwordx4 v15, s[32:35], s72 offen lds
    buffer_load_dwordx4 v15, s[32:35], s73 offen offset:1024 lds
    s_lshl_b32 s6, s6, 15
    s_lshl_b32 s70, s63, 10
    s_add_u32 s70, s70, s6
    s_add_u32 s92, s70, 9437184
    s_lshl_b32 s4, s64, 1
    s_add_u32 s4, s4, s69
    s_cmp_eq_u32 s4, 4
    s_cselect_b32 s50, 0x10001, 0
    s_mov_b32 s51, s50
    v_mov_b32 v14, 0xbf803f80
    s_mov_b32 s70, 3
    s_barrier
    ds_read_b128 v[32:35], v4 offset:0
    ds_read_b64_tr_b16 v[48:49], v6 offset:0
    ds_read_b64_tr_b16 v[50:51], v6 offset:1024
    ds_read_b128 v[36:39], v4 offset:2048
    ds_read_b64_tr_b16 v[52:53], v7 offset:0
    ds_read_b64_tr_b16 v[54:55], v7 offset:1024
    ds_read_b128 v[40:43], v4 offset:4096
    ds_read_b64_tr_b16 v[56:57], v8 offset:0
    ds_read_b64_tr_b16 v[58:59], v8 offset:1024
    ds_read_b128 v[44:47], v4 offset:6144
    ds_read_b64_tr_b16 v[60:61], v9 offset:0
    ds_read_b64_tr_b16 v[62:63], v9 offset:1024
    s_waitcnt lgkmcnt(0)
.p2align 3
L_p1_loopA:
    v_mfma_f32_16x16x32_bf16 v[132:135], v[32:35], v[52:55], v[132:135]
    ds_read_b128 v[64:67], v5 offset:0
    ds_read_b64_tr_b16 v[80:81], v6 offset:8192
    v_cndmask_b32 v48, v48, v14, s[50:51]
    v_mfma_f32_16x16x32_bf16 v[148:151], v[36:39], v[52:55], v[148:151]
    ds_read_b64_tr_b16 v[82:83], v6 offset:9216
    ds_read_b128 v[68:71], v5 offset:2048
    v_cndmask_b32 v49, v49, v14, s[50:51]
    v_mfma_f32_16x16x32_bf16 v[164:167], v[40:43], v[52:55], v[164:167]
    ds_read_b64_tr_b16 v[84:85], v7 offset:8192
    ds_read_b64_tr_b16 v[86:87], v7 offset:9216
    v_cndmask_b32 v50, v50, v14, s[50:51]
    v_mfma_f32_16x16x32_bf16 v[180:183], v[44:47], v[52:55], v[180:183]
    ds_read_b128 v[72:75], v5 offset:4096
    ds_read_b64_tr_b16 v[88:89], v8 offset:8192
    v_cndmask_b32 v51, v51, v14, s[50:51]
    v_mfma_f32_16x16x32_bf16 v[136:139], v[32:35], v[56:59], v[136:139]
    ds_read_b64_tr_b16 v[90:91], v8 offset:9216
    ds_read_b128 v[76:79], v5 offset:6144
    v_mfma_f32_16x16x32_bf16 v[152:155], v[36:39], v[56:59], v[152:155]
    ds_read_b64_tr_b16 v[92:93], v9 offset:8192
    ds_read_b64_tr_b16 v[94:95], v9 offset:9216
    v_mfma_f32_16x16x32_bf16 v[168:171], v[40:43], v[56:59], v[168:171]
    v_mfma_f32_16x16x32_bf16 v[184:187], v[44:47], v[56:59], v[184:187]
    v_mfma_f32_16x16x32_bf16 v[140:143], v[32:35], v[60:63], v[140:143]
    v_mfma_f32_16x16x32_bf16 v[156:159], v[36:39], v[60:63], v[156:159]
    v_mfma_f32_16x16x32_bf16 v[172:175], v[40:43], v[60:63], v[172:175]
    v_mfma_f32_16x16x32_bf16 v[188:191], v[44:47], v[60:63], v[188:191]
    v_mfma_f32_16x16x32_bf16 v[128:131], v[32:35], v[48:51], v[128:131]
    v_mfma_f32_16x16x32_bf16 v[144:147], v[36:39], v[48:51], v[144:147]
    v_mfma_f32_16x16x32_bf16 v[160:163], v[40:43], v[48:51], v[160:163]
    v_mfma_f32_16x16x32_bf16 v[176:179], v[44:47], v[48:51], v[176:179]
    s_waitcnt lgkmcnt(0)
    s_barrier
    v_mfma_f32_16x16x32_bf16 v[132:135], v[64:67], v[84:87], v[132:135]
    ds_read_b128 v[32:35], v4 offset:32768
    ds_read_b64_tr_b16 v[48:49], v6 offset:32768
    v_cndmask_b32 v80, v80, v14, s[50:51]
    v_mfma_f32_16x16x32_bf16 v[148:151], v[68:71], v[84:87], v[148:151]
    ds_read_b64_tr_b16 v[50:51], v6 offset:33792
    ds_read_b128 v[36:39], v4 offset:34816
    v_cndmask_b32 v81, v81, v14, s[50:51]
    v_mfma_f32_16x16x32_bf16 v[164:167], v[72:75], v[84:87], v[164:167]
    ds_read_b64_tr_b16 v[52:53], v7 offset:32768
    ds_read_b64_tr_b16 v[54:55], v7 offset:33792
    v_cndmask_b32 v82, v82, v14, s[50:51]
    v_mfma_f32_16x16x32_bf16 v[180:183], v[76:79], v[84:87], v[180:183]
    ds_read_b128 v[40:43], v4 offset:36864
    ds_read_b64_tr_b16 v[56:57], v8 offset:32768
    v_cndmask_b32 v83, v83, v14, s[50:51]
    v_mfma_f32_16x16x32_bf16 v[136:139], v[64:67], v[88:91], v[136:139]
    ds_read_b64_tr_b16 v[58:59], v8 offset:33792
    ds_read_b128 v[44:47], v4 offset:38912
    v_mfma_f32_16x16x32_bf16 v[152:155], v[68:71], v[88:91], v[152:155]
    ds_read_b64_tr_b16 v[60:61], v9 offset:32768
    ds_read_b64_tr_b16 v[62:63], v9 offset:33792
    v_mfma_f32_16x16x32_bf16 v[168:171], v[72:75], v[88:91], v[168:171]
    v_mfma_f32_16x16x32_bf16 v[184:187], v[76:79], v[88:91], v[184:187]
    v_mfma_f32_16x16x32_bf16 v[140:143], v[64:67], v[92:95], v[140:143]
    v_mfma_f32_16x16x32_bf16 v[156:159], v[68:71], v[92:95], v[156:159]
    v_mfma_f32_16x16x32_bf16 v[172:175], v[72:75], v[92:95], v[172:175]
    v_mfma_f32_16x16x32_bf16 v[188:191], v[76:79], v[92:95], v[188:191]
    v_mfma_f32_16x16x32_bf16 v[128:131], v[64:67], v[80:83], v[128:131]
    v_mfma_f32_16x16x32_bf16 v[144:147], v[68:71], v[80:83], v[144:147]
    v_mfma_f32_16x16x32_bf16 v[160:163], v[72:75], v[80:83], v[160:163]
    v_mfma_f32_16x16x32_bf16 v[176:179], v[76:79], v[80:83], v[176:179]
    s_waitcnt lgkmcnt(0)
    v_mfma_f32_16x16x32_bf16 v[132:135], v[32:35], v[52:55], v[132:135]
    ds_read_b128 v[64:67], v5 offset:32768
    ds_read_b64_tr_b16 v[80:81], v6 offset:40960
    v_cndmask_b32 v48, v48, v14, s[50:51]
    v_mfma_f32_16x16x32_bf16 v[148:151], v[36:39], v[52:55], v[148:151]
    ds_read_b64_tr_b16 v[82:83], v6 offset:41984
    ds_read_b128 v[68:71], v5 offset:34816
    v_cndmask_b32 v49, v49, v14, s[50:51]
    v_mfma_f32_16x16x32_bf16 v[164:167], v[40:43], v[52:55], v[164:167]
    ds_read_b64_tr_b16 v[84:85], v7 offset:40960
    ds_read_b64_tr_b16 v[86:87], v7 offset:41984
    v_cndmask_b32 v50, v50, v14, s[50:51]
    v_mfma_f32_16x16x32_bf16 v[180:183], v[44:47], v[52:55], v[180:183]
    ds_read_b128 v[72:75], v5 offset:36864
    ds_read_b64_tr_b16 v[88:89], v8 offset:40960
    v_cndmask_b32 v51, v51, v14, s[50:51]
    v_mfma_f32_16x16x32_bf16 v[136:139], v[32:35], v[56:59], v[136:139]
    ds_read_b64_tr_b16 v[90:91], v8 offset:41984
    ds_read_b128 v[76:79], v5 offset:38912
    v_mfma_f32_16x16x32_bf16 v[152:155], v[36:39], v[56:59], v[152:155]
    ds_read_b64_tr_b16 v[92:93], v9 offset:40960
    ds_read_b64_tr_b16 v[94:95], v9 offset:41984
    v_mfma_f32_16x16x32_bf16 v[168:171], v[40:43], v[56:59], v[168:171]
    v_mfma_f32_16x16x32_bf16 v[184:187], v[44:47], v[56:59], v[184:187]
    v_xor_b32 v4, 0x10000, v4
    v_mfma_f32_16x16x32_bf16 v[140:143], v[32:35], v[60:63], v[140:143]
    v_xor_b32 v5, 0x10000, v5
    v_mfma_f32_16x16x32_bf16 v[156:159], v[36:39], v[60:63], v[156:159]
    v_xor_b32 v6, 0x10000, v6
    v_mfma_f32_16x16x32_bf16 v[172:175], v[40:43], v[60:63], v[172:175]
    v_xor_b32 v7, 0x10000, v7
    v_mfma_f32_16x16x32_bf16 v[188:191], v[44:47], v[60:63], v[188:191]
    v_xor_b32 v8, 0x10000, v8
    v_mfma_f32_16x16x32_bf16 v[128:131], v[32:35], v[48:51], v[128:131]
    v_xor_b32 v9, 0x10000, v9
    v_mfma_f32_16x16x32_bf16 v[144:147], v[36:39], v[48:51], v[144:147]
    v_mfma_f32_16x16x32_bf16 v[160:163], v[40:43], v[48:51], v[160:163]
    v_mfma_f32_16x16x32_bf16 v[176:179], v[44:47], v[48:51], v[176:179]
    s_waitcnt lgkmcnt(0)
    s_barrier
    v_mfma_f32_16x16x32_bf16 v[132:135], v[64:67], v[84:87], v[132:135]
    ds_read_b128 v[32:35], v4 offset:0
    ds_read_b64_tr_b16 v[48:49], v6 offset:0
    v_cndmask_b32 v80, v80, v14, s[50:51]
    v_mfma_f32_16x16x32_bf16 v[148:151], v[68:71], v[84:87], v[148:151]
    ds_read_b64_tr_b16 v[50:51], v6 offset:1024
    ds_read_b128 v[36:39], v4 offset:2048
    v_cndmask_b32 v81, v81, v14, s[50:51]
    v_mfma_f32_16x16x32_bf16 v[164:167], v[72:75], v[84:87], v[164:167]
    ds_read_b64_tr_b16 v[52:53], v7 offset:0
    ds_read_b64_tr_b16 v[54:55], v7 offset:1024
    v_cndmask_b32 v82, v82, v14, s[50:51]
    v_mfma_f32_16x16x32_bf16 v[180:183], v[76:79], v[84:87], v[180:183]
    ds_read_b128 v[40:43], v4 offset:4096
    ds_read_b64_tr_b16 v[56:57], v8 offset:0
    v_cndmask_b32 v83, v83, v14, s[50:51]
    v_mfma_f32_16x16x32_bf16 v[136:139], v[64:67], v[88:91], v[136:139]
    ds_read_b64_tr_b16 v[58:59], v8 offset:1024
    ds_read_b128 v[44:47], v4 offset:6144
    v_mfma_f32_16x16x32_bf16 v[152:155], v[68:71], v[88:91], v[152:155]
    ds_read_b64_tr_b16 v[60:61], v9 offset:0
    ds_read_b64_tr_b16 v[62:63], v9 offset:1024
    v_mfma_f32_16x16x32_bf16 v[168:171], v[72:75], v[88:91], v[168:171]
    v_mfma_f32_16x16x32_bf16 v[184:187], v[76:79], v[88:91], v[184:187]
    s_sub_u32 s70, s70, 1
    v_mfma_f32_16x16x32_bf16 v[140:143], v[64:67], v[92:95], v[140:143]
    v_mfma_f32_16x16x32_bf16 v[156:159], v[68:71], v[92:95], v[156:159]
    v_mfma_f32_16x16x32_bf16 v[172:175], v[72:75], v[92:95], v[172:175]
    v_mfma_f32_16x16x32_bf16 v[188:191], v[76:79], v[92:95], v[188:191]
    v_mfma_f32_16x16x32_bf16 v[128:131], v[64:67], v[80:83], v[128:131]
    v_mfma_f32_16x16x32_bf16 v[144:147], v[68:71], v[80:83], v[144:147]
    v_mfma_f32_16x16x32_bf16 v[160:163], v[72:75], v[80:83], v[160:163]
    v_mfma_f32_16x16x32_bf16 v[176:179], v[76:79], v[80:83], v[176:179]
    s_waitcnt lgkmcnt(0)
    s_cbranch_scc0 L_p1_loopA
    s_waitcnt vmcnt(0)
    ds_read_b64_tr_b16 v[208:209], v20
    ds_read_b64_tr_b16 v[210:211], v20 offset:256
    ds_read_b64_tr_b16 v[212:213], v20 offset:32
    ds_read_b64_tr_b16 v[214:215], v20 offset:288
    s_mov_b32 s12, 0
    s_mov_b32 s13, 1
    s_waitcnt lgkmcnt(0)
    s_cmp_lt_u32 s64, 2
    s_cselect_b32 s70, 1.0, -1.0
    v_mov_b32 v10, s70
    v_mov_b32 v11, s70
    s_lshl_b32 s4, s64, 1
    s_add_u32 s4, s4, s69
    s_cmp_eq_u32 s4, 4
    s_cselect_b32 s5, 0x10001, 0
    s_mov_b32 vcc_lo, s5
    s_mov_b32 vcc_hi, s5
    v_mov_b32 v3, 1.0
    v_cndmask_b32 v10, v10, v3, vcc
    s_lshl_b32 s5, s63, 1
    s_add_u32 s5, s5, s68
    s_cmp_eq_u32 s5, 0
    s_cbranch_scc0 L_p1_noR
    s_lshl_b32 s6, s4, 8
    s_add_u32 s6, s6, 9961472
    s_mov_b64 exec, 0xffff
    v_lshl_add_u32 v224, v0, 2, s6
    v_fma_f32 v216, v10, v176, v160
    v_mov_b32 v160, 0
    v_mov_b32 v176, 0
    v_fma_f32 v217, v11, v180, v164
    v_mov_b32 v164, 0
    v_mov_b32 v180, 0
    v_fma_f32 v218, v11, v184, v168
    v_mov_b32 v168, 0
    v_mov_b32 v184, 0
    v_fma_f32 v219, v11, v188, v172
    v_mov_b32 v172, 0
    v_mov_b32 v188, 0
    s_mov_b64 exec, -1
L_p1_noR:
    s_lshr_b32 s6, s64, 1
    s_lshl_b32 s6, s6, 19
    s_and_b32 s4, s4, 3
    s_lshl_b32 s4, s4, 16
    s_lshl_b32 s5, s5, 10
    s_add_u32 s73, s4, s5
    s_add_u32 s73, s73, s6
    s_add_u32 s73, s73, 6291456
    s_add_u32 s74, s73, 0x40000
    v_fmac_f32 v128, v10, v176
    v_fmac_f32 v144, v10, v160
    v_fmac_f32 v129, v10, v177
    v_fmac_f32 v145, v10, v161
    v_fmac_f32 v130, v10, v178
    v_fmac_f32 v146, v10, v162
    v_fmac_f32 v131, v10, v179
    v_fmac_f32 v147, v10, v163
    v_fma_f32 v160, v10, v144, v128
    v_fma_f32 v176, -v10, v144, v128
    v_fma_f32 v161, v10, v145, v129
    v_fma_f32 v177, -v10, v145, v129
    v_fma_f32 v162, v10, v146, v130
    v_fma_f32 v178, -v10, v146, v130
    v_fma_f32 v163, v10, v147, v131
    v_fma_f32 v179, -v10, v147, v131
    v_fmac_f32 v132, v11, v180
    v_fmac_f32 v148, v11, v164
    v_fmac_f32 v133, v11, v181
    v_fmac_f32 v149, v11, v165
    v_fmac_f32 v134, v11, v182
    v_fmac_f32 v150, v11, v166
    v_fmac_f32 v135, v11, v183
    v_fmac_f32 v151, v11, v167
    v_fma_f32 v164, v11, v148, v132
    v_fma_f32 v180, -v11, v148, v132
    v_fma_f32 v165, v11, v149, v133
    v_fma_f32 v181, -v11, v149, v133
    v_fma_f32 v166, v11, v150, v134
    v_fma_f32 v182, -v11, v150, v134
    v_fma_f32 v167, v11, v151, v135
    v_fma_f32 v183, -v11, v151, v135
    v_cvt_pk_bf16_f32 v192, v160, v161
    v_cvt_pk_bf16_f32 v193, v162, v163
    v_cvt_pk_bf16_f32 v194, v164, v165
    v_cvt_pk_bf16_f32 v195, v166, v167
    s_nop 1
    v_permlane16_swap_b32 v192, v194
    v_permlane16_swap_b32 v193, v195
    v_cvt_pk_bf16_f32 v196, v176, v177
    v_cvt_pk_bf16_f32 v197, v178, v179
    v_cvt_pk_bf16_f32 v198, v180, v181
    v_cvt_pk_bf16_f32 v199, v182, v183
    s_nop 1
    v_permlane16_swap_b32 v196, v198
    v_permlane16_swap_b32 v197, v199
    v_fmac_f32 v136, v11, v184
    v_fmac_f32 v152, v11, v168
    v_fmac_f32 v137, v11, v185
    v_fmac_f32 v153, v11, v169
    v_fmac_f32 v138, v11, v186
    v_fmac_f32 v154, v11, v170
    v_fmac_f32 v139, v11, v187
    v_fmac_f32 v155, v11, v171
    v_fma_f32 v168, v11, v152, v136
    v_fma_f32 v184, -v11, v152, v136
    v_fma_f32 v169, v11, v153, v137
    v_fma_f32 v185, -v11, v153, v137
    v_fma_f32 v170, v11, v154, v138
    v_fma_f32 v186, -v11, v154, v138
    v_fma_f32 v171, v11, v155, v139
    v_fma_f32 v187, -v11, v155, v139
    v_fmac_f32 v140, v11, v188
    v_fmac_f32 v156, v11, v172
    v_fmac_f32 v141, v11, v189
    v_fmac_f32 v157, v11, v173
    v_fmac_f32 v142, v11, v190
    v_fmac_f32 v158, v11, v174
    v_fmac_f32 v143, v11, v191
    v_fmac_f32 v159, v11, v175
    v_fma_f32 v172, v11, v156, v140
    v_fma_f32 v188, -v11, v156, v140
    v_fma_f32 v173, v11, v157, v141
    v_fma_f32 v189, -v11, v157, v141
    v_fma_f32 v174, v11, v158, v142
    v_fma_f32 v190, -v11, v158, v142
    v_fma_f32 v175, v11, v159, v143
    v_fma_f32 v191, -v11, v159, v143
    v_cvt_pk_bf16_f32 v200, v168, v169
    v_cvt_pk_bf16_f32 v201, v170, v171
    v_cvt_pk_bf16_f32 v202, v172, v173
    v_cvt_pk_bf16_f32 v203, v174, v175
    s_nop 1
    v_permlane16_swap_b32 v200, v202
    v_permlane16_swap_b32 v201, v203
    v_cvt_pk_bf16_f32 v204, v184, v185
    v_cvt_pk_bf16_f32 v205, v186, v187
    v_cvt_pk_bf16_f32 v206, v188, v189
    v_cvt_pk_bf16_f32 v207, v190, v191
    s_nop 1
    v_permlane16_swap_b32 v204, v206
    v_permlane16_swap_b32 v205, v207
L_p1_cdone:
    s_add_u32 s58, s58, 1
    v_mov_b64 v[64:65], 0
    v_mov_b64 v[66:67], 0
    v_mov_b64 v[68:69], 0
    v_mov_b64 v[70:71], 0
    v_mov_b64 v[72:73], 0
    v_mov_b64 v[74:75], 0
    v_mov_b64 v[76:77], 0
    v_mov_b64 v[78:79], 0
    v_mov_b64 v[80:81], 0
    v_mov_b64 v[82:83], 0
    v_mov_b64 v[84:85], 0
    v_mov_b64 v[86:87], 0
    v_mov_b64 v[88:89], 0
    v_mov_b64 v[90:91], 0
    v_mov_b64 v[92:93], 0
    v_mov_b64 v[94:95], 0
    s_cmp_eq_u32 s62, 3
    s_cbranch_scc1 L_p1_join
    s_and_b32 s4, s63, 7
    s_cmp_eq_u32 s63, 8
    s_cselect_b32 s4, 9, s4
    s_lshl_b32 s4, s4, 7
    s_and_b32 s5, s63, 8
    s_lshl_b32 s6, s62, 2
    s_add_u32 s5, s5, s6
    s_add_u32 s4, s4, s5
    s_sub_u32 s4, s4, 4
    s_and_b32 s5, s63, 1
    s_lshl_b32 s5, s5, 2
    s_lshr_b32 s6, s63, 1
    s_lshl_b32 s6, s6, 13
    s_add_u32 s5, s5, s6
    s_add_u32 s5, s5, 1024
    s_cmp_eq_u32 s62, 0
    s_cselect_b32 s4, s5, s4
    s_cselect_b32 s6, 15, -1
    s_lshl_b32 s5, s64, 16
    s_add_u32 s4, s4, s5
    s_add_u32 s4, s4, 10485760
    s_cmp_lg_u32 s12, 0
    s_cbranch_scc1 L_p1_join
    v_lshlrev_b32 v1, 11, v122
    v_mov_b32 v2, s58
    v_mov_b32 v3, 161792
    v_mov_b32 v4, 1
    s_mov_b64 exec, 1
    s_waitcnt vmcnt(0)
    ds_add_rtn_u32 v4, v3, v4
    s_waitcnt lgkmcnt(0)
    v_readfirstlane_b32 s5, v4
    s_mov_b32 exec_lo, s6
    s_cmp_eq_u32 s5, 3
    s_cbranch_scc0 L_s1_noflag
    buffer_store_dword v2, v1, s[16:19], s4 offen sc1
L_s1_noflag:
    s_mov_b64 exec, -1
L_p1_join:
    s_setprio 0
    s_mov_b64 s[14:15], s[54:55]
    s_barrier
    ds_read_b128 v[96:99], v123
    ds_read_b128 v[112:115], v120
    ds_read_b128 v[100:103], v123 offset:1024
    ds_read_b128 v[104:107], v117
    ds_read_b128 v[108:111], v118 offset:1024
    s_add_u32 s4, s90, 8192
    s_add_u32 m0, s91, 8192
    s_nop 0
    buffer_load_dwordx4 v120, s[16:19], s4 offen sc1 lds
    buffer_load_dwordx4 v120, s[16:19], s4 offen offset:1024 sc1 lds
    s_waitcnt lgkmcnt(3)
    v_mfma_f32_32x32x16_bf16 v[0:15], v[112:115], v[96:99], 0
    s_waitcnt lgkmcnt(2)
    v_mfma_f32_32x32x16_bf16 v[16:31], v[112:115], v[100:103], 0
    s_nop 0
    s_add_u32 s4, s90, 16384
    s_add_u32 m0, s91, 16384
    s_nop 0
    buffer_load_dwordx4 v120, s[16:19], s4 offen sc1 lds
    buffer_load_dwordx4 v120, s[16:19], s4 offen offset:1024 sc1 lds
    s_nop 3
    v_max3_f32 v123, v0, v1, v2
    v_max3_f32 v123, v123, v3, v4
    v_max3_f32 v123, v123, v5, v6
    v_max3_f32 v123, v123, v7, v8
    v_max3_f32 v123, v123, v9, v10
    v_max3_f32 v123, v123, v11, v12
    v_max3_f32 v123, v123, v13, v14
    v_max_f32 v123, v123, v15
    v_mov_b32 v125, v123
    s_nop 1
    v_permlane32_swap_b32 v123, v125
    v_max_f32 v123, v123, v125
    v_sub_f32 v32, 3267887104, v123
    v_sub_f32 v33, 3267887104, v123
    v_mov_b64 v[34:35], v[32:33]
    v_mov_b64 v[36:37], v[32:33]
    v_mov_b64 v[38:39], v[32:33]
    v_mov_b64 v[40:41], v[32:33]
    v_mov_b64 v[42:43], v[32:33]
    v_mov_b64 v[44:45], v[32:33]
    v_mov_b64 v[46:47], v[32:33]
    s_waitcnt lgkmcnt(0)
    s_nop 0
    v_mfma_f32_32x32x16_bf16 v[0:15], v[104:107], v[96:99], v[32:47]
    v_max3_f32 v124, v16, v17, v18
    v_max3_f32 v124, v124, v19, v20
    v_max3_f32 v124, v124, v21, v22
    v_max3_f32 v124, v124, v23, v24
    v_max3_f32 v124, v124, v25, v26
    v_max3_f32 v124, v124, v27, v28
    v_max3_f32 v124, v124, v29, v30
    v_max_f32 v124, v124, v31
    v_mov_b32 v125, v124
    s_nop 1
    v_permlane32_swap_b32 v124, v125
    v_max_f32 v124, v124, v125
    v_sub_f32 v48, 3267887104, v124
    v_sub_f32 v49, 3267887104, v124
    v_mov_b64 v[50:51], v[48:49]
    v_mov_b64 v[52:53], v[48:49]
    v_mov_b64 v[54:55], v[48:49]
    v_mov_b64 v[56:57], v[48:49]
    v_mov_b64 v[58:59], v[48:49]
    v_mov_b64 v[60:61], v[48:49]
    v_mov_b64 v[62:63], v[48:49]
.p2align 3
    s_setprio 3
    v_exp_f32 v0, v0
    v_exp_f32 v1, v1
    ds_read_b128 v[112:115], v118 offset:1280
    v_exp_f32 v2, v2
    v_exp_f32 v3, v3
    v_exp_f32 v4, v4
    v_mfma_f32_32x32x16_bf16 v[16:31], v[104:107], v[100:103], v[48:63]
    ds_read_b128 v[104:107], v117 offset:2048
    v_exp_f32 v5, v5
    v_exp_f32 v6, v6
    v_exp_f32 v7, v7
    v_exp_f32 v8, v8
    v_exp_f32 v9, v9
    s_waitcnt lgkmcnt(2)
    v_smfmac_f32_32x32x32_bf16 v[64:79], v[108:111], v[0:7], v116
    v_exp_f32 v10, v10
    v_exp_f32 v11, v11
    v_exp_f32 v12, v12
    s_add_u32 s4, s90, 24576
    s_add_u32 m0, s91, 24576
    s_nop 0
    buffer_load_dwordx4 v120, s[16:19], s4 offen sc1 lds
    buffer_load_dwordx4 v120, s[16:19], s4 offen offset:1024 sc1 lds
    v_exp_f32 v13, v13
    v_exp_f32 v14, v14
    v_exp_f32 v15, v15
    s_setprio 2
    v_exp_f32 v16, v16
    v_exp_f32 v17, v17
    s_waitcnt lgkmcnt(0)
    v_smfmac_f32_32x32x32_bf16 v[64:79], v[112:115], v[8:15], v116
    v_exp_f32 v18, v18
    v_exp_f32 v19, v19
    v_exp_f32 v20, v20
    v_mfma_f32_32x32x16_bf16 v[0:15], v[104:107], v[96:99], v[32:47]
    v_exp_f32 v21, v21
    v_exp_f32 v22, v22
    v_exp_f32 v23, v23
    v_exp_f32 v24, v24
    v_exp_f32 v25, v25
    v_smfmac_f32_32x32x32_bf16 v[80:95], v[108:111], v[16:23], v116
    ds_read_b128 v[108:111], v118 offset:3072
    v_exp_f32 v26, v26
    v_exp_f32 v27, v27
    v_exp_f32 v28, v28
    v_exp_f32 v29, v29
    v_exp_f32 v30, v30
    v_exp_f32 v31, v31
    s_setprio 1
    v_exp_f32 v0, v0
    v_exp_f32 v1, v1
    v_smfmac_f32_32x32x32_bf16 v[80:95], v[112:115], v[24:31], v116
    s_mov_b64 exec, s[48:49]
    ds_read_b128 v[112:115], v117 offset:3328
    s_mov_b64 exec, -1
    v_exp_f32 v2, v2
    v_exp_f32 v3, v3
    v_exp_f32 v4, v4
    v_mfma_f32_32x32x16_bf16 v[16:31], v[104:107], v[100:103], v[48:63]
    ds_read_b128 v[104:107], v117 offset:4096
    v_exp_f32 v5, v5
    v_exp_f32 v6, v6
    v_exp_f32 v7, v7
    v_exp_f32 v8, v8
    v_exp_f32 v9, v9
    s_waitcnt lgkmcnt(2)
    v_smfmac_f32_32x32x32_bf16 v[64:79], v[108:111], v[0:7], v116
    v_exp_f32 v10, v10
    v_exp_f32 v11, v11
    v_exp_f32 v12, v12
    s_cmp_eq_u32 s12, 0
    s_cbranch_scc1 L_at_nokv0
    buffer_store_dwordx4 v[192:195], v224, s[16:19], s75 offen sc1
    buffer_store_dwordx4 v[196:199], v225, s[16:19], s75 offen sc1
    s_add_u32 s75, s75, s74
L_at_nokv0:
    v_exp_f32 v13, v13
    v_exp_f32 v14, v14
    v_exp_f32 v15, v15
    s_setprio 0
    v_exp_f32 v16, v16
    v_exp_f32 v17, v17
    s_waitcnt lgkmcnt(0)
    v_smfmac_f32_32x32x32_bf16 v[64:79], v[112:115], v[8:15], v116
    v_exp_f32 v18, v18
    v_exp_f32 v19, v19
    v_exp_f32 v20, v20
    v_mfma_f32_32x32x16_bf16 v[0:15], v[104:107], v[96:99], v[32:47]
    v_exp_f32 v21, v21
    v_exp_f32 v22, v22
    v_exp_f32 v23, v23
    v_exp_f32 v24, v24
    v_exp_f32 v25, v25
    v_smfmac_f32_32x32x32_bf16 v[80:95], v[108:111], v[16:23], v116
    s_mov_b64 exec, s[48:49]
    ds_read_b128 v[108:111], v117 offset:5120
    s_mov_b64 exec, -1
    v_exp_f32 v26, v26
    v_exp_f32 v27, v27
    v_exp_f32 v28, v28
    s_cmp_eq_u32 s12, 0
    s_cbranch_scc1 L_at_nokv1
    buffer_store_dwordx4 v[200:203], v224, s[16:19], s75 offen sc1
    buffer_store_dwordx4 v[204:207], v225, s[16:19], s75 offen sc1
    s_add_u32 s75, s75, s74
L_at_nokv1:
    v_exp_f32 v29, v29
    v_exp_f32 v30, v30
    v_exp_f32 v31, v31
    s_setprio 3
    v_exp_f32 v0, v0
    v_exp_f32 v1, v1
    v_smfmac_f32_32x32x32_bf16 v[80:95], v[112:115], v[24:31], v116
    s_mov_b64 exec, s[48:49]
    ds_read_b128 v[112:115], v117 offset:5376
    s_mov_b64 exec, -1
    v_exp_f32 v2, v2
    v_exp_f32 v3, v3
    v_exp_f32 v4, v4
    v_mfma_f32_32x32x16_bf16 v[16:31], v[104:107], v[100:103], v[48:63]
    ds_read_b128 v[104:107], v117 offset:6144
    v_exp_f32 v5, v5
    v_exp_f32 v6, v6
    v_exp_f32 v7, v7
    v_exp_f32 v8, v8
    v_exp_f32 v9, v9
    s_waitcnt lgkmcnt(2)
    v_smfmac_f32_32x32x32_bf16 v[64:79], v[108:111], v[0:7], v116
    v_exp_f32 v10, v10
    v_exp_f32 v11, v11
    v_exp_f32 v12, v12
    s_cmp_eq_u32 s12, 0
    s_cbranch_scc1 L_at_nokv2
    buffer_store_dwordx4 v[208:211], v224, s[16:19], s75 offen sc1
    buffer_store_dwordx4 v[212:215], v225, s[16:19], s75 offen sc1
    s_add_u32 s75, s75, s74
L_at_nokv2:
    v_exp_f32 v13, v13
    v_exp_f32 v14, v14
    v_exp_f32 v15, v15
    s_setprio 2
    v_exp_f32 v16, v16
    v_exp_f32 v17, v17
    s_waitcnt lgkmcnt(0)
    v_smfmac_f32_32x32x32_bf16 v[64:79], v[112:115], v[8:15], v116
    v_exp_f32 v18, v18
    v_exp_f32 v19, v19
    v_exp_f32 v20, v20
    v_mfma_f32_32x32x16_bf16 v[0:15], v[104:107], v[96:99], v[32:47]
    v_exp_f32 v21, v21
    v_exp_f32 v22, v22
    v_exp_f32 v23, v23
    v_exp_f32 v24, v24
    v_exp_f32 v25, v25
    v_smfmac_f32_32x32x32_bf16 v[80:95], v[108:111], v[16:23], v116
    s_mov_b64 exec, s[48:49]
    ds_read_b128 v[108:111], v117 offset:7168
    s_mov_b64 exec, -1
    v_exp_f32 v26, v26
    v_exp_f32 v27, v27
    v_exp_f32 v28, v28
    s_cmp_eq_u32 s12, 0
    s_cbranch_scc1 L_at_nokv3
    buffer_store_dwordx4 v[216:219], v224, s[16:19], s75 offen sc1
    buffer_store_dwordx4 v[220:223], v225, s[16:19], s75 offen sc1
    s_add_u32 s75, s75, s74
L_at_nokv3:
    v_exp_f32 v29, v29
    v_exp_f32 v30, v30
    v_exp_f32 v31, v31
    s_waitcnt vmcnt(8)
    s_cmp_lg_u32 s12, 0
    s_cbranch_scc1 L_at_w3
    s_waitcnt vmcnt(0)
L_at_w3:
    s_barrier
    s_setprio 1
    v_exp_f32 v0, v0
    v_exp_f32 v1, v1
    v_smfmac_f32_32x32x32_bf16 v[80:95], v[112:115], v[24:31], v116
    s_mov_b64 exec, s[48:49]
    ds_read_b128 v[112:115], v117 offset:7424
    s_mov_b64 exec, -1
    v_exp_f32 v2, v2
    v_exp_f32 v3, v3
    v_exp_f32 v4, v4
    v_mfma_f32_32x32x16_bf16 v[16:31], v[104:107], v[100:103], v[48:63]
    ds_read_b128 v[104:107], v117 offset:8192
    v_exp_f32 v5, v5
    v_exp_f32 v6, v6
    v_exp_f32 v7, v7
    v_exp_f32 v8, v8
    v_exp_f32 v9, v9
    s_waitcnt lgkmcnt(2)
    v_smfmac_f32_32x32x32_bf16 v[64:79], v[108:111], v[0:7], v116
    v_exp_f32 v10, v10
    v_exp_f32 v11, v11
    v_exp_f32 v12, v12
    v_exp_f32 v13, v13
    v_exp_f32 v14, v14
    v_exp_f32 v15, v15
    s_setprio 0
    v_exp_f32 v16, v16
    v_exp_f32 v17, v17
    s_waitcnt lgkmcnt(0)
    v_smfmac_f32_32x32x32_bf16 v[64:79], v[112:115], v[8:15], v116
    v_exp_f32 v18, v18
    v_exp_f32 v19, v19
    v_exp_f32 v20, v20
    v_mfma_f32_32x32x16_bf16 v[0:15], v[104:107], v[96:99], v[32:47]
    v_exp_f32 v21, v21
    v_exp_f32 v22, v22
    v_exp_f32 v23, v23
    v_exp_f32 v24, v24
    v_exp_f32 v25, v25
    v_smfmac_f32_32x32x32_bf16 v[80:95], v[108:111], v[16:23], v116
    s_mov_b64 exec, s[48:49]
    ds_read_b128 v[108:111], v117 offset:9216
    s_mov_b64 exec, -1
    v_exp_f32 v26, v26
    v_exp_f32 v27, v27
    v_exp_f32 v28, v28
    v_exp_f32 v29, v29
    v_exp_f32 v30, v30
    v_exp_f32 v31, v31
    s_setprio 3
    v_exp_f32 v0, v0
    v_exp_f32 v1, v1
    v_smfmac_f32_32x32x32_bf16 v[80:95], v[112:115], v[24:31], v116
    s_mov_b64 exec, s[48:49]
    ds_read_b128 v[112:115], v117 offset:9472
    s_mov_b64 exec, -1
    v_exp_f32 v2, v2
    v_exp_f32 v3, v3
    v_exp_f32 v4, v4
    v_mfma_f32_32x32x16_bf16 v[16:31], v[104:107], v[100:103], v[48:63]
    ds_read_b128 v[104:107], v117 offset:10240
    v_exp_f32 v5, v5
    v_exp_f32 v6, v6
    v_exp_f32 v7, v7
    v_exp_f32 v8, v8
    v_exp_f32 v9, v9
    s_waitcnt lgkmcnt(2)
    v_smfmac_f32_32x32x32_bf16 v[64:79], v[108:111], v[0:7], v116
    v_exp_f32 v10, v10
    v_exp_f32 v11, v11
    v_exp_f32 v12, v12
    s_cmp_eq_u32 s13, 0
    s_cbranch_scc0 L_at_a1s0
L_at_a1r0:
    v_exp_f32 v13, v13
    v_exp_f32 v14, v14
    v_exp_f32 v15, v15
    s_setprio 2
    v_exp_f32 v16, v16
    v_exp_f32 v17, v17
    s_waitcnt lgkmcnt(0)
    v_smfmac_f32_32x32x32_bf16 v[64:79], v[112:115], v[8:15], v116
    v_exp_f32 v18, v18
    v_exp_f32 v19, v19
    v_exp_f32 v20, v20
    v_mfma_f32_32x32x16_bf16 v[0:15], v[104:107], v[96:99], v[32:47]
    v_exp_f32 v21, v21
    v_exp_f32 v22, v22
    v_exp_f32 v23, v23
    v_exp_f32 v24, v24
    v_exp_f32 v25, v25
    v_smfmac_f32_32x32x32_bf16 v[80:95], v[108:111], v[16:23], v116
    s_mov_b64 exec, s[48:49]
    ds_read_b128 v[108:111], v117 offset:11264
    s_mov_b64 exec, -1
    v_exp_f32 v26, v26
    v_exp_f32 v27, v27
    v_exp_f32 v28, v28
    s_cmp_eq_u32 s13, 0
    s_cbranch_scc0 L_at_a1s1
L_at_a1r1:
    v_exp_f32 v29, v29
    v_exp_f32 v30, v30
    v_exp_f32 v31, v31
    s_setprio 1
    v_exp_f32 v0, v0
    v_exp_f32 v1, v1
    v_smfmac_f32_32x32x32_bf16 v[80:95], v[112:115], v[24:31], v116
    s_mov_b64 exec, s[48:49]
    ds_read_b128 v[112:115], v117 offset:11520
    s_mov_b64 exec, -1
    v_exp_f32 v2, v2
    v_exp_f32 v3, v3
    v_exp_f32 v4, v4
    v_mfma_f32_32x32x16_bf16 v[16:31], v[104:107], v[100:103], v[48:63]
    ds_read_b128 v[104:107], v117 offset:12288
    v_exp_f32 v5, v5
    v_exp_f32 v6, v6
    v_exp_f32 v7, v7
    v_exp_f32 v8, v8
    v_exp_f32 v9, v9
    s_waitcnt lgkmcnt(2)
    v_smfmac_f32_32x32x32_bf16 v[64:79], v[108:111], v[0:7], v116
    v_exp_f32 v10, v10
    v_exp_f32 v11, v11
    v_exp_f32 v12, v12
    s_cmp_eq_u32 s13, 0
    s_cbranch_scc0 L_at_a1s2
L_at_a1r2:
    s_cmp_eq_u32 s12, 0
    s_cbranch_scc0 L_at_cnt1
L_at_cnt1r:
    v_exp_f32 v13, v13
    v_exp_f32 v14, v14
    v_exp_f32 v15, v15
    s_setprio 0
    v_exp_f32 v16, v16
    v_exp_f32 v17, v17
    s_waitcnt lgkmcnt(0)
    v_smfmac_f32_32x32x32_bf16 v[64:79], v[112:115], v[8:15], v116
    v_exp_f32 v18, v18
    v_exp_f32 v19, v19
    v_exp_f32 v20, v20
    v_mfma_f32_32x32x16_bf16 v[0:15], v[104:107], v[96:99], v[32:47]
    v_exp_f32 v21, v21
    v_exp_f32 v22, v22
    v_exp_f32 v23, v23
    v_exp_f32 v24, v24
    v_exp_f32 v25, v25
    v_smfmac_f32_32x32x32_bf16 v[80:95], v[108:111], v[16:23], v116
    s_mov_b64 exec, s[48:49]
    ds_read_b128 v[108:111], v117 offset:13312
    s_mov_b64 exec, -1
    v_exp_f32 v26, v26
    v_exp_f32 v27, v27
    v_exp_f32 v28, v28
    s_cmp_eq_u32 s13, 0
    s_cbranch_scc0 L_at_a1s3
L_at_a1r3:
    s_cmp_eq_u32 s12, 0
    s_cbranch_scc0 L_at_pub1
L_at_pub1r:
    v_exp_f32 v29, v29
    v_exp_f32 v30, v30
    v_exp_f32 v31, v31
    s_setprio 3
    v_exp_f32 v0, v0
    v_exp_f32 v1, v1
    v_smfmac_f32_32x32x32_bf16 v[80:95], v[112:115], v[24:31], v116
    s_mov_b64 exec, s[48:49]
    ds_read_b128 v[112:115], v117 offset:13568
    s_mov_b64 exec, -1
    v_exp_f32 v2, v2
    v_exp_f32 v3, v3
    v_exp_f32 v4, v4
    v_mfma_f32_32x32x16_bf16 v[16:31], v[104:107], v[100:103], v[48:63]
    ds_read_b128 v[104:107], v117 offset:14336
    v_exp_f32 v5, v5
    v_exp_f32 v6, v6
    v_exp_f32 v7, v7
    v_exp_f32 v8, v8
    v_exp_f32 v9, v9
    s_waitcnt lgkmcnt(2)
    v_smfmac_f32_32x32x32_bf16 v[64:79], v[108:111], v[0:7], v116
    v_exp_f32 v10, v10
    v_exp_f32 v11, v11
    v_exp_f32 v12, v12
    s_cmp_eq_u32 s13, 0
    s_cbranch_scc0 L_at_a1s4
L_at_a1r4:
    v_mov_b64 v[228:229], -1
    v_mov_b64 v[230:231], -1
    buffer_store_dwordx4 v[228:231], v120, s[16:19], s82 offen sc1
    v_exp_f32 v13, v13
    v_exp_f32 v14, v14
    v_exp_f32 v15, v15
    s_setprio 2
    v_exp_f32 v16, v16
    v_exp_f32 v17, v17
    s_waitcnt lgkmcnt(0)
    v_smfmac_f32_32x32x32_bf16 v[64:79], v[112:115], v[8:15], v116
    v_exp_f32 v18, v18
    v_exp_f32 v19, v19
    v_exp_f32 v20, v20
    v_mfma_f32_32x32x16_bf16 v[0:15], v[104:107], v[96:99], v[32:47]
    v_exp_f32 v21, v21
    v_exp_f32 v22, v22
    v_exp_f32 v23, v23
    v_exp_f32 v24, v24
    v_exp_f32 v25, v25
    v_smfmac_f32_32x32x32_bf16 v[80:95], v[108:111], v[16:23], v116
    s_mov_b64 exec, s[48:49]
    ds_read_b128 v[108:111], v117 offset:15360
    s_mov_b64 exec, -1
    v_exp_f32 v26, v26
    v_exp_f32 v27, v27
    v_exp_f32 v28, v28
    v_exp_f32 v29, v29
    v_exp_f32 v30, v30
    v_exp_f32 v31, v31
    s_setprio 1
    v_exp_f32 v0, v0
    v_exp_f32 v1, v1
    v_smfmac_f32_32x32x32_bf16 v[80:95], v[112:115], v[24:31], v116
    s_mov_b64 exec, s[48:49]
    ds_read_b128 v[112:115], v117 offset:15616
    s_mov_b64 exec, -1
    v_exp_f32 v2, v2
    v_exp_f32 v3, v3
    v_exp_f32 v4, v4
    v_mfma_f32_32x32x16_bf16 v[16:31], v[104:107], v[100:103], v[48:63]
    ds_read_b128 v[104:107], v117 offset:16384
    v_exp_f32 v5, v5
    v_exp_f32 v6, v6
    v_exp_f32 v7, v7
    v_exp_f32 v8, v8
    v_exp_f32 v9, v9
    s_waitcnt lgkmcnt(2)
    v_smfmac_f32_32x32x32_bf16 v[64:79], v[108:111], v[0:7], v116
    v_exp_f32 v10, v10
    v_exp_f32 v11, v11
    v_exp_f32 v12, v12
    buffer_load_dwordx4 v[128:131], v121, s[24:27], 0 offen offset:0
    v_exp_f32 v13, v13
    v_exp_f32 v14, v14
    v_exp_f32 v15, v15
    s_setprio 0
    v_exp_f32 v16, v16
    v_exp_f32 v17, v17
    s_waitcnt lgkmcnt(0)
    v_smfmac_f32_32x32x32_bf16 v[64:79], v[112:115], v[8:15], v116
    v_exp_f32 v18, v18
    v_exp_f32 v19, v19
    v_exp_f32 v20, v20
    v_mfma_f32_32x32x16_bf16 v[0:15], v[104:107], v[96:99], v[32:47]
    v_exp_f32 v21, v21
    v_exp_f32 v22, v22
    v_exp_f32 v23, v23
    v_exp_f32 v24, v24
    v_exp_f32 v25, v25
    v_smfmac_f32_32x32x32_bf16 v[80:95], v[108:111], v[16:23], v116
    s_mov_b64 exec, s[48:49]
    ds_read_b128 v[108:111], v117 offset:17408
    s_mov_b64 exec, -1
    v_exp_f32 v26, v26
    v_exp_f32 v27, v27
    v_exp_f32 v28, v28
    v_exp_f32 v29, v29
    v_exp_f32 v30, v30
    v_exp_f32 v31, v31
    s_setprio 3
    v_exp_f32 v0, v0
    v_exp_f32 v1, v1
    v_smfmac_f32_32x32x32_bf16 v[80:95], v[112:115], v[24:31], v116
    s_mov_b64 exec, s[48:49]
    ds_read_b128 v[112:115], v117 offset:17664
    s_mov_b64 exec, -1
    v_exp_f32 v2, v2
    v_exp_f32 v3, v3
    v_exp_f32 v4, v4
    v_mfma_f32_32x32x16_bf16 v[16:31], v[104:107], v[100:103], v[48:63]
    ds_read_b128 v[104:107], v117 offset:18432
    v_exp_f32 v5, v5
    v_exp_f32 v6, v6
    v_exp_f32 v7, v7
    v_exp_f32 v8, v8
    v_exp_f32 v9, v9
    s_waitcnt lgkmcnt(2)
    v_smfmac_f32_32x32x32_bf16 v[64:79], v[108:111], v[0:7], v116
    v_exp_f32 v10, v10
    v_exp_f32 v11, v11
    v_exp_f32 v12, v12
    v_exp_f32 v13, v13
    v_exp_f32 v14, v14
    v_exp_f32 v15, v15
    s_setprio 2
    v_exp_f32 v16, v16
    v_exp_f32 v17, v17
    s_waitcnt lgkmcnt(0)
    v_smfmac_f32_32x32x32_bf16 v[64:79], v[112:115], v[8:15], v116
    v_exp_f32 v18, v18
    v_exp_f32 v19, v19
    v_exp_f32 v20, v20
    v_mfma_f32_32x32x16_bf16 v[0:15], v[104:107], v[96:99], v[32:47]
    v_exp_f32 v21, v21
    v_exp_f32 v22, v22
    v_exp_f32 v23, v23
    v_exp_f32 v24, v24
    v_exp_f32 v25, v25
    v_smfmac_f32_32x32x32_bf16 v[80:95], v[108:111], v[16:23], v116
    s_mov_b64 exec, s[48:49]
    ds_read_b128 v[108:111], v117 offset:19456
    s_mov_b64 exec, -1
    v_exp_f32 v26, v26
    v_exp_f32 v27, v27
    v_exp_f32 v28, v28
    v_exp_f32 v29, v29
    v_exp_f32 v30, v30
    v_exp_f32 v31, v31
    s_setprio 1
    v_exp_f32 v0, v0
    v_exp_f32 v1, v1
    v_smfmac_f32_32x32x32_bf16 v[80:95], v[112:115], v[24:31], v116
    s_mov_b64 exec, s[48:49]
    ds_read_b128 v[112:115], v117 offset:19712
    s_mov_b64 exec, -1
    v_exp_f32 v2, v2
    v_exp_f32 v3, v3
    v_exp_f32 v4, v4
    v_mfma_f32_32x32x16_bf16 v[16:31], v[104:107], v[100:103], v[48:63]
    ds_read_b128 v[104:107], v117 offset:20480
    v_exp_f32 v5, v5
    v_exp_f32 v6, v6
    v_exp_f32 v7, v7
    v_exp_f32 v8, v8
    v_exp_f32 v9, v9
    s_waitcnt lgkmcnt(2)
    v_smfmac_f32_32x32x32_bf16 v[64:79], v[108:111], v[0:7], v116
    v_exp_f32 v10, v10
    v_exp_f32 v11, v11
    v_exp_f32 v12, v12
    v_bfe_u32 v123, v122, 2, 2
    v_and_b32 v125, 3, v122
    v_lshlrev_b32 v125, 2, v125
    v_lshl_add_u32 v125, v123, 7, v125
    v_exp_f32 v13, v13
    v_exp_f32 v14, v14
    v_exp_f32 v15, v15
    s_setprio 0
    v_exp_f32 v16, v16
    v_exp_f32 v17, v17
    s_waitcnt lgkmcnt(0)
    v_smfmac_f32_32x32x32_bf16 v[64:79], v[112:115], v[8:15], v116
    v_exp_f32 v18, v18
    v_exp_f32 v19, v19
    v_exp_f32 v20, v20
    v_mfma_f32_32x32x16_bf16 v[0:15], v[104:107], v[96:99], v[32:47]
    v_exp_f32 v21, v21
    v_exp_f32 v22, v22
    v_exp_f32 v23, v23
    v_exp_f32 v24, v24
    v_exp_f32 v25, v25
    v_smfmac_f32_32x32x32_bf16 v[80:95], v[108:111], v[16:23], v116
    s_mov_b64 exec, s[48:49]
    ds_read_b128 v[108:111], v117 offset:21504
    s_mov_b64 exec, -1
    v_exp_f32 v26, v26
    v_exp_f32 v27, v27
    v_exp_f32 v28, v28
    buffer_load_dword v123, v125, s[16:19], s15 offen offset:512 sc1
    v_exp_f32 v29, v29
    v_exp_f32 v30, v30
    v_exp_f32 v31, v31
    s_setprio 3
    v_exp_f32 v0, v0
    v_exp_f32 v1, v1
    v_smfmac_f32_32x32x32_bf16 v[80:95], v[112:115], v[24:31], v116
    s_mov_b64 exec, s[48:49]
    ds_read_b128 v[112:115], v117 offset:21760
    s_mov_b64 exec, -1
    v_exp_f32 v2, v2
    v_exp_f32 v3, v3
    v_exp_f32 v4, v4
    v_mfma_f32_32x32x16_bf16 v[16:31], v[104:107], v[100:103], v[48:63]
    ds_read_b128 v[104:107], v117 offset:22528
    v_exp_f32 v5, v5
    v_exp_f32 v6, v6
    v_exp_f32 v7, v7
    v_exp_f32 v8, v8
    v_exp_f32 v9, v9
    s_waitcnt lgkmcnt(2)
    v_smfmac_f32_32x32x32_bf16 v[64:79], v[108:111], v[0:7], v116
    v_exp_f32 v10, v10
    v_exp_f32 v11, v11
    v_exp_f32 v12, v12
    v_exp_f32 v13, v13
    v_exp_f32 v14, v14
    v_exp_f32 v15, v15
    s_setprio 2
    v_exp_f32 v16, v16
    v_exp_f32 v17, v17
    s_waitcnt lgkmcnt(0)
    v_smfmac_f32_32x32x32_bf16 v[64:79], v[112:115], v[8:15], v116
    v_exp_f32 v18, v18
    v_exp_f32 v19, v19
    v_exp_f32 v20, v20
    v_mfma_f32_32x32x16_bf16 v[0:15], v[104:107], v[96:99], v[32:47]
    v_exp_f32 v21, v21
    v_exp_f32 v22, v22
    v_exp_f32 v23, v23
    v_exp_f32 v24, v24
    v_exp_f32 v25, v25
    v_smfmac_f32_32x32x32_bf16 v[80:95], v[108:111], v[16:23], v116
    s_mov_b64 exec, s[48:49]
    ds_read_b128 v[108:111], v117 offset:23552
    s_mov_b64 exec, -1
    v_exp_f32 v26, v26
    v_exp_f32 v27, v27
    v_exp_f32 v28, v28
    v_exp_f32 v29, v29
    v_exp_f32 v30, v30
    v_exp_f32 v31, v31
    s_setprio 1
    v_exp_f32 v0, v0
    v_exp_f32 v1, v1
    v_smfmac_f32_32x32x32_bf16 v[80:95], v[112:115], v[24:31], v116
    s_mov_b64 exec, s[48:49]
    ds_read_b128 v[112:115], v117 offset:23808
    s_mov_b64 exec, -1
    v_exp_f32 v2, v2
    v_exp_f32 v3, v3
    v_exp_f32 v4, v4
    v_mfma_f32_32x32x16_bf16 v[16:31], v[104:107], v[100:103], v[48:63]
    ds_read_b128 v[104:107], v117 offset:24576
    v_exp_f32 v5, v5
    v_exp_f32 v6, v6
    v_exp_f32 v7, v7
    v_exp_f32 v8, v8
    v_exp_f32 v9, v9
    s_waitcnt lgkmcnt(2)
    v_smfmac_f32_32x32x32_bf16 v[64:79], v[108:111], v[0:7], v116
    v_exp_f32 v10, v10
    v_exp_f32 v11, v11
    v_exp_f32 v12, v12
    s_waitcnt vmcnt(0)
    v_cmp_ne_u32 vcc, s58, v123
    s_cbranch_vccnz L_at_f1retry
L_at_f1ok:
    v_mov_b32 v123, 161796
    v_mov_b32 v124, 1
    s_mov_b64 exec, 1
    ds_add_rtn_u32 v124, v123, v124
    s_mov_b64 exec, -1
    s_add_u32 s4, s90, 32768
    s_add_u32 m0, s91, 32768
    s_nop 0
    buffer_load_dwordx4 v120, s[16:19], s4 offen sc1 lds
    buffer_load_dwordx4 v120, s[16:19], s4 offen offset:1024 sc1 lds
    v_exp_f32 v13, v13
    v_exp_f32 v14, v14
    v_exp_f32 v15, v15
    s_setprio 0
    v_exp_f32 v16, v16
    v_exp_f32 v17, v17
    s_waitcnt lgkmcnt(0)
    v_smfmac_f32_32x32x32_bf16 v[64:79], v[112:115], v[8:15], v116
    v_exp_f32 v18, v18
    v_exp_f32 v19, v19
    v_exp_f32 v20, v20
    v_mfma_f32_32x32x16_bf16 v[0:15], v[104:107], v[96:99], v[32:47]
    v_exp_f32 v21, v21
    v_exp_f32 v22, v22
    v_exp_f32 v23, v23
    v_exp_f32 v24, v24
    v_exp_f32 v25, v25
    v_smfmac_f32_32x32x32_bf16 v[80:95], v[108:111], v[16:23], v116
    s_mov_b64 exec, s[48:49]
    ds_read_b128 v[108:111], v117 offset:25600
    s_mov_b64 exec, -1
    v_exp_f32 v26, v26
    v_exp_f32 v27, v27
    v_exp_f32 v28, v28
    v_readfirstlane_b32 s4, v124
    s_nop 0
    s_cmp_eq_u32 s4, 7
    s_cbranch_scc1 L_at_pub2
L_at_pub2r:
    s_add_u32 s4, s90, 40960
    s_add_u32 m0, s91, 40960
    s_nop 0
    buffer_load_dwordx4 v120, s[16:19], s4 offen sc1 lds
    buffer_load_dwordx4 v120, s[16:19], s4 offen offset:1024 sc1 lds
    v_exp_f32 v29, v29
    v_exp_f32 v30, v30
    v_exp_f32 v31, v31
    s_setprio 3
    v_exp_f32 v0, v0
    v_exp_f32 v1, v1
    v_smfmac_f32_32x32x32_bf16 v[80:95], v[112:115], v[24:31], v116
    s_mov_b64 exec, s[48:49]
    ds_read_b128 v[112:115], v117 offset:25856
    s_mov_b64 exec, -1
    v_exp_f32 v2, v2
    v_exp_f32 v3, v3
    v_exp_f32 v4, v4
    v_mfma_f32_32x32x16_bf16 v[16:31], v[104:107], v[100:103], v[48:63]
    ds_read_b128 v[104:107], v117 offset:26624
    v_exp_f32 v5, v5
    v_exp_f32 v6, v6
    v_exp_f32 v7, v7
    v_exp_f32 v8, v8
    v_exp_f32 v9, v9
    s_waitcnt lgkmcnt(2)
    v_smfmac_f32_32x32x32_bf16 v[64:79], v[108:111], v[0:7], v116
    v_exp_f32 v10, v10
    v_exp_f32 v11, v11
    v_exp_f32 v12, v12
    s_add_u32 s4, s90, 49152
    s_add_u32 m0, s91, 49152
    s_nop 0
    buffer_load_dwordx4 v120, s[16:19], s4 offen sc1 lds
    buffer_load_dwordx4 v120, s[16:19], s4 offen offset:1024 sc1 lds
    v_exp_f32 v13, v13
    v_exp_f32 v14, v14
    v_exp_f32 v15, v15
    s_setprio 2
    v_exp_f32 v16, v16
    v_exp_f32 v17, v17
    s_waitcnt lgkmcnt(0)
    v_smfmac_f32_32x32x32_bf16 v[64:79], v[112:115], v[8:15], v116
    v_exp_f32 v18, v18
    v_exp_f32 v19, v19
    v_exp_f32 v20, v20
    v_mfma_f32_32x32x16_bf16 v[0:15], v[104:107], v[96:99], v[32:47]
    v_exp_f32 v21, v21
    v_exp_f32 v22, v22
    v_exp_f32 v23, v23
    v_exp_f32 v24, v24
    v_exp_f32 v25, v25
    v_smfmac_f32_32x32x32_bf16 v[80:95], v[108:111], v[16:23], v116
    s_mov_b64 exec, s[48:49]
    ds_read_b128 v[108:111], v117 offset:27648
    s_mov_b64 exec, -1
    v_exp_f32 v26, v26
    v_exp_f32 v27, v27
    v_exp_f32 v28, v28
    s_add_u32 s4, s90, 57344
    s_add_u32 m0, s91, 57344
    s_nop 0
    buffer_load_dwordx4 v120, s[16:19], s4 offen sc1 lds
    buffer_load_dwordx4 v120, s[16:19], s4 offen offset:1024 sc1 lds
    v_exp_f32 v29, v29
    v_exp_f32 v30, v30
    v_exp_f32 v31, v31
    s_setprio 1
    v_exp_f32 v0, v0
    v_exp_f32 v1, v1
    v_smfmac_f32_32x32x32_bf16 v[80:95], v[112:115], v[24:31], v116
    s_mov_b64 exec, s[48:49]
    ds_read_b128 v[112:115], v117 offset:27904
    s_mov_b64 exec, -1
    v_exp_f32 v2, v2
    v_exp_f32 v3, v3
    v_exp_f32 v4, v4
    v_mfma_f32_32x32x16_bf16 v[16:31], v[104:107], v[100:103], v[48:63]
    ds_read_b128 v[104:107], v117 offset:28672
    v_exp_f32 v5, v5
    v_exp_f32 v6, v6
    v_exp_f32 v7, v7
    v_exp_f32 v8, v8
    v_exp_f32 v9, v9
    s_waitcnt lgkmcnt(2)
    v_smfmac_f32_32x32x32_bf16 v[64:79], v[108:111], v[0:7], v116
    v_exp_f32 v10, v10
    v_exp_f32 v11, v11
    v_exp_f32 v12, v12
    buffer_load_dwordx4 v[144:147], v121, s[28:31], 0 offen offset:0
    v_exp_f32 v13, v13
    v_exp_f32 v14, v14
    v_exp_f32 v15, v15
    s_setprio 0
    v_exp_f32 v16, v16
    v_exp_f32 v17, v17
    s_waitcnt lgkmcnt(0)
    v_smfmac_f32_32x32x32_bf16 v[64:79], v[112:115], v[8:15], v116
    v_exp_f32 v18, v18
    v_exp_f32 v19, v19
    v_exp_f32 v20, v20
    v_mfma_f32_32x32x16_bf16 v[0:15], v[104:107], v[96:99], v[32:47]
    v_exp_f32 v21, v21
    v_exp_f32 v22, v22
    v_exp_f32 v23, v23
    v_exp_f32 v24, v24
    v_exp_f32 v25, v25
    v_smfmac_f32_32x32x32_bf16 v[80:95], v[108:111], v[16:23], v116
    s_mov_b64 exec, s[48:49]
    ds_read_b128 v[108:111], v117 offset:29696
    s_mov_b64 exec, -1
    v_exp_f32 v26, v26
    v_exp_f32 v27, v27
    v_exp_f32 v28, v28
    v_exp_f32 v29, v29
    v_exp_f32 v30, v30
    v_exp_f32 v31, v31
    s_setprio 3
    v_exp_f32 v0, v0
    v_exp_f32 v1, v1
    v_smfmac_f32_32x32x32_bf16 v[80:95], v[112:115], v[24:31], v116
    s_mov_b64 exec, s[48:49]
    ds_read_b128 v[112:115], v117 offset:29952
    s_mov_b64 exec, -1
    v_exp_f32 v2, v2
    v_exp_f32 v3, v3
    v_exp_f32 v4, v4
    v_mfma_f32_32x32x16_bf16 v[16:31], v[104:107], v[100:103], v[48:63]
    ds_read_b128 v[104:107], v117 offset:30720
    v_exp_f32 v5, v5
    v_exp_f32 v6, v6
    v_exp_f32 v7, v7
    v_exp_f32 v8, v8
    v_exp_f32 v9, v9
    s_waitcnt lgkmcnt(2)
    v_smfmac_f32_32x32x32_bf16 v[64:79], v[108:111], v[0:7], v116
    v_exp_f32 v10, v10
    v_exp_f32 v11, v11
    v_exp_f32 v12, v12
    v_exp_f32 v13, v13
    v_exp_f32 v14, v14
    v_exp_f32 v15, v15
    s_setprio 2
    v_exp_f32 v16, v16
    v_exp_f32 v17, v17
    s_waitcnt lgkmcnt(0)
    v_smfmac_f32_32x32x32_bf16 v[64:79], v[112:115], v[8:15], v116
    v_exp_f32 v18, v18
    v_exp_f32 v19, v19
    v_exp_f32 v20, v20
    v_mfma_f32_32x32x16_bf16 v[0:15], v[104:107], v[96:99], v[32:47]
    v_exp_f32 v21, v21
    v_exp_f32 v22, v22
    v_exp_f32 v23, v23
    v_exp_f32 v24, v24
    v_exp_f32 v25, v25
    v_smfmac_f32_32x32x32_bf16 v[80:95], v[108:111], v[16:23], v116
    s_mov_b64 exec, s[48:49]
    ds_read_b128 v[108:111], v117 offset:31744
    s_mov_b64 exec, -1
    v_exp_f32 v26, v26
    v_exp_f32 v27, v27
    v_exp_f32 v28, v28
    v_exp_f32 v29, v29
    v_exp_f32 v30, v30
    v_exp_f32 v31, v31
    s_waitcnt vmcnt(1)
    s_barrier
    s_setprio 1
    v_exp_f32 v0, v0
    v_exp_f32 v1, v1
    v_smfmac_f32_32x32x32_bf16 v[80:95], v[112:115], v[24:31], v116
    s_mov_b64 exec, s[48:49]
    ds_read_b128 v[112:115], v117 offset:32000
    s_mov_b64 exec, -1
    v_exp_f32 v2, v2
    v_exp_f32 v3, v3
    v_exp_f32 v4, v4
    v_mfma_f32_32x32x16_bf16 v[16:31], v[104:107], v[100:103], v[48:63]
    ds_read_b128 v[104:107], v117 offset:32768
    v_exp_f32 v5, v5
    v_exp_f32 v6, v6
    v_exp_f32 v7, v7
    v_exp_f32 v8, v8
    v_exp_f32 v9, v9
    s_waitcnt lgkmcnt(2)
    v_smfmac_f32_32x32x32_bf16 v[64:79], v[108:111], v[0:7], v116
    v_exp_f32 v10, v10
    v_exp_f32 v11, v11
    v_exp_f32 v12, v12
    v_exp_f32 v13, v13
    v_exp_f32 v14, v14
    v_exp_f32 v15, v15
    s_setprio 0
    v_exp_f32 v16, v16
    v_exp_f32 v17, v17
    s_waitcnt lgkmcnt(0)
    v_smfmac_f32_32x32x32_bf16 v[64:79], v[112:115], v[8:15], v116
    v_exp_f32 v18, v18
    v_exp_f32 v19, v19
    v_exp_f32 v20, v20
    v_mfma_f32_32x32x16_bf16 v[0:15], v[104:107], v[96:99], v[32:47]
    v_exp_f32 v21, v21
    v_exp_f32 v22, v22
    v_exp_f32 v23, v23
    v_exp_f32 v24, v24
    v_exp_f32 v25, v25
    v_smfmac_f32_32x32x32_bf16 v[80:95], v[108:111], v[16:23], v116
    s_mov_b64 exec, s[48:49]
    ds_read_b128 v[108:111], v117 offset:33792
    s_mov_b64 exec, -1
    v_exp_f32 v26, v26
    v_exp_f32 v27, v27
    v_exp_f32 v28, v28
    v_exp_f32 v29, v29
    v_exp_f32 v30, v30
    v_exp_f32 v31, v31
    s_setprio 3
    v_exp_f32 v0, v0
    v_exp_f32 v1, v1
    v_smfmac_f32_32x32x32_bf16 v[80:95], v[112:115], v[24:31], v116
    s_mov_b64 exec, s[48:49]
    ds_read_b128 v[112:115], v117 offset:34048
    s_mov_b64 exec, -1
    v_exp_f32 v2, v2
    v_exp_f32 v3, v3
    v_exp_f32 v4, v4
    v_mfma_f32_32x32x16_bf16 v[16:31], v[104:107], v[100:103], v[48:63]
    ds_read_b128 v[104:107], v117 offset:34816
    v_exp_f32 v5, v5
    v_exp_f32 v6, v6
    v_exp_f32 v7, v7
    v_exp_f32 v8, v8
    v_exp_f32 v9, v9
    s_waitcnt lgkmcnt(2)
    v_smfmac_f32_32x32x32_bf16 v[64:79], v[108:111], v[0:7], v116
    v_exp_f32 v10, v10
    v_exp_f32 v11, v11
    v_exp_f32 v12, v12
    buffer_load_dwordx4 v[132:135], v121, s[24:27], 0 offen offset:32
    v_exp_f32 v13, v13
    v_exp_f32 v14, v14
    v_exp_f32 v15, v15
    s_setprio 2
    v_exp_f32 v16, v16
    v_exp_f32 v17, v17
    s_waitcnt lgkmcnt(0)
    v_smfmac_f32_32x32x32_bf16 v[64:79], v[112:115], v[8:15], v116
    v_exp_f32 v18, v18
    v_exp_f32 v19, v19
    v_exp_f32 v20, v20
    v_mfma_f32_32x32x16_bf16 v[0:15], v[104:107], v[96:99], v[32:47]
    v_exp_f32 v21, v21
    v_exp_f32 v22, v22
    v_exp_f32 v23, v23
    v_exp_f32 v24, v24
    v_exp_f32 v25, v25
    v_smfmac_f32_32x32x32_bf16 v[80:95], v[108:111], v[16:23], v116
    s_mov_b64 exec, s[48:49]
    ds_read_b128 v[108:111], v117 offset:35840
    s_mov_b64 exec, -1
    v_exp_f32 v26, v26
    v_exp_f32 v27, v27
    v_exp_f32 v28, v28
    v_exp_f32 v29, v29
    v_exp_f32 v30, v30
    v_exp_f32 v31, v31
    s_setprio 1
    v_exp_f32 v0, v0
    v_exp_f32 v1, v1
    v_smfmac_f32_32x32x32_bf16 v[80:95], v[112:115], v[24:31], v116
    s_mov_b64 exec, s[48:49]
    ds_read_b128 v[112:115], v117 offset:36096
    s_mov_b64 exec, -1
    v_exp_f32 v2, v2
    v_exp_f32 v3, v3
    v_exp_f32 v4, v4
    v_mfma_f32_32x32x16_bf16 v[16:31], v[104:107], v[100:103], v[48:63]
    ds_read_b128 v[104:107], v117 offset:36864
    v_exp_f32 v5, v5
    v_exp_f32 v6, v6
    v_exp_f32 v7, v7
    v_exp_f32 v8, v8
    v_exp_f32 v9, v9
    s_waitcnt lgkmcnt(2)
    v_smfmac_f32_32x32x32_bf16 v[64:79], v[108:111], v[0:7], v116
    v_exp_f32 v10, v10
    v_exp_f32 v11, v11
    v_exp_f32 v12, v12
    buffer_load_dwordx4 v[136:139], v121, s[24:27], 0 offen offset:64
    v_exp_f32 v13, v13
    v_exp_f32 v14, v14
    v_exp_f32 v15, v15
    s_setprio 0
    v_exp_f32 v16, v16
    v_exp_f32 v17, v17
    s_waitcnt lgkmcnt(0)
    v_smfmac_f32_32x32x32_bf16 v[64:79], v[112:115], v[8:15], v116
    v_exp_f32 v18, v18
    v_exp_f32 v19, v19
    v_exp_f32 v20, v20
    v_mfma_f32_32x32x16_bf16 v[0:15], v[104:107], v[96:99], v[32:47]
    v_exp_f32 v21, v21
    v_exp_f32 v22, v22
    v_exp_f32 v23, v23
    v_exp_f32 v24, v24
    v_exp_f32 v25, v25
    v_smfmac_f32_32x32x32_bf16 v[80:95], v[108:111], v[16:23], v116
    s_mov_b64 exec, s[48:49]
    ds_read_b128 v[108:111], v117 offset:37888
    s_mov_b64 exec, -1
    v_exp_f32 v26, v26
    v_exp_f32 v27, v27
    v_exp_f32 v28, v28
    s_mov_b32 s92, 10027008
    buffer_load_dword v160, v120, s[16:19], s92 offen offset:0 sc1
    buffer_load_dword v161, v120, s[16:19], s92 offen offset:1024 sc1
    v_exp_f32 v29, v29
    v_exp_f32 v30, v30
    v_exp_f32 v31, v31
    s_setprio 3
    v_exp_f32 v0, v0
    v_exp_f32 v1, v1
    v_smfmac_f32_32x32x32_bf16 v[80:95], v[112:115], v[24:31], v116
    s_mov_b64 exec, s[48:49]
    ds_read_b128 v[112:115], v117 offset:38144
    s_mov_b64 exec, -1
    v_exp_f32 v2, v2
    v_exp_f32 v3, v3
    v_exp_f32 v4, v4
    v_mfma_f32_32x32x16_bf16 v[16:31], v[104:107], v[100:103], v[48:63]
    ds_read_b128 v[104:107], v117 offset:38912
    v_exp_f32 v5, v5
    v_exp_f32 v6, v6
    v_exp_f32 v7, v7
    v_exp_f32 v8, v8
    v_exp_f32 v9, v9
    s_waitcnt lgkmcnt(2)
    v_smfmac_f32_32x32x32_bf16 v[64:79], v[108:111], v[0:7], v116
    v_exp_f32 v10, v10
    v_exp_f32 v11, v11
    v_exp_f32 v12, v12
    buffer_load_dwordx4 v[140:143], v121, s[24:27], 0 offen offset:96
    v_exp_f32 v13, v13
    v_exp_f32 v14, v14
    v_exp_f32 v15, v15
    s_setprio 2
    v_exp_f32 v16, v16
    v_exp_f32 v17, v17
    s_waitcnt lgkmcnt(0)
    v_smfmac_f32_32x32x32_bf16 v[64:79], v[112:115], v[8:15], v116
    v_exp_f32 v18, v18
    v_exp_f32 v19, v19
    v_exp_f32 v20, v20
    v_mfma_f32_32x32x16_bf16 v[0:15], v[104:107], v[96:99], v[32:47]
    v_exp_f32 v21, v21
    v_exp_f32 v22, v22
    v_exp_f32 v23, v23
    v_exp_f32 v24, v24
    v_exp_f32 v25, v25
    v_smfmac_f32_32x32x32_bf16 v[80:95], v[108:111], v[16:23], v116
    s_mov_b64 exec, s[48:49]
    ds_read_b128 v[108:111], v117 offset:39936
    s_mov_b64 exec, -1
    v_exp_f32 v26, v26
    v_exp_f32 v27, v27
    v_exp_f32 v28, v28
    buffer_load_dword v162, v120, s[16:19], s92 offen offset:2048 sc1
    buffer_load_dword v163, v120, s[16:19], s92 offen offset:3072 sc1
    v_exp_f32 v29, v29
    v_exp_f32 v30, v30
    v_exp_f32 v31, v31
    s_setprio 1
    v_exp_f32 v0, v0
    v_exp_f32 v1, v1
    v_smfmac_f32_32x32x32_bf16 v[80:95], v[112:115], v[24:31], v116
    s_mov_b64 exec, s[48:49]
    ds_read_b128 v[112:115], v117 offset:40192
    s_mov_b64 exec, -1
    v_exp_f32 v2, v2
    v_exp_f32 v3, v3
    v_exp_f32 v4, v4
    v_mfma_f32_32x32x16_bf16 v[16:31], v[104:107], v[100:103], v[48:63]
    ds_read_b128 v[104:107], v117 offset:40960
    v_exp_f32 v5, v5
    v_exp_f32 v6, v6
    v_exp_f32 v7, v7
    v_exp_f32 v8, v8
    v_exp_f32 v9, v9
    s_waitcnt lgkmcnt(2)
    v_smfmac_f32_32x32x32_bf16 v[64:79], v[108:111], v[0:7], v116
    v_exp_f32 v10, v10
    v_exp_f32 v11, v11
    v_exp_f32 v12, v12
    buffer_load_dwordx4 v[148:151], v121, s[28:31], 0 offen offset:32
    v_exp_f32 v13, v13
    v_exp_f32 v14, v14
    v_exp_f32 v15, v15
    s_setprio 0
    v_exp_f32 v16, v16
    v_exp_f32 v17, v17
    s_waitcnt lgkmcnt(0)
    v_smfmac_f32_32x32x32_bf16 v[64:79], v[112:115], v[8:15], v116
    v_exp_f32 v18, v18
    v_exp_f32 v19, v19
    v_exp_f32 v20, v20
    v_mfma_f32_32x32x16_bf16 v[0:15], v[104:107], v[96:99], v[32:47]
    v_exp_f32 v21, v21
    v_exp_f32 v22, v22
    v_exp_f32 v23, v23
    v_exp_f32 v24, v24
    v_exp_f32 v25, v25
    v_smfmac_f32_32x32x32_bf16 v[80:95], v[108:111], v[16:23], v116
    s_mov_b64 exec, s[48:49]
    ds_read_b128 v[108:111], v117 offset:41984
    s_mov_b64 exec, -1
    v_exp_f32 v26, v26
    v_exp_f32 v27, v27
    v_exp_f32 v28, v28
    v_exp_f32 v29, v29
    v_exp_f32 v30, v30
    v_exp_f32 v31, v31
    s_setprio 3
    v_exp_f32 v0, v0
    v_exp_f32 v1, v1
    v_smfmac_f32_32x32x32_bf16 v[80:95], v[112:115], v[24:31], v116
    s_mov_b64 exec, s[48:49]
    ds_read_b128 v[112:115], v117 offset:42240
    s_mov_b64 exec, -1
    v_exp_f32 v2, v2
    v_exp_f32 v3, v3
    v_exp_f32 v4, v4
    v_mfma_f32_32x32x16_bf16 v[16:31], v[104:107], v[100:103], v[48:63]
    ds_read_b128 v[104:107], v117 offset:43008
    v_exp_f32 v5, v5
    v_exp_f32 v6, v6
    v_exp_f32 v7, v7
    v_exp_f32 v8, v8
    v_exp_f32 v9, v9
    s_waitcnt lgkmcnt(2)
    v_smfmac_f32_32x32x32_bf16 v[64:79], v[108:111], v[0:7], v116
    v_exp_f32 v10, v10
    v_exp_f32 v11, v11
    v_exp_f32 v12, v12
    buffer_load_dwordx4 v[152:155], v121, s[28:31], 0 offen offset:64
    v_exp_f32 v13, v13
    v_exp_f32 v14, v14
    v_exp_f32 v15, v15
    s_setprio 2
    v_exp_f32 v16, v16
    v_exp_f32 v17, v17
    s_waitcnt lgkmcnt(0)
    v_smfmac_f32_32x32x32_bf16 v[64:79], v[112:115], v[8:15], v116
    v_exp_f32 v18, v18
    v_exp_f32 v19, v19
    v_exp_f32 v20, v20
    v_mfma_f32_32x32x16_bf16 v[0:15], v[104:107], v[96:99], v[32:47]
    v_exp_f32 v21, v21
    v_exp_f32 v22, v22
    v_exp_f32 v23, v23
    v_exp_f32 v24, v24
    v_exp_f32 v25, v25
    v_smfmac_f32_32x32x32_bf16 v[80:95], v[108:111], v[16:23], v116
    s_mov_b64 exec, s[48:49]
    ds_read_b128 v[108:111], v117 offset:44032
    s_mov_b64 exec, -1
    v_exp_f32 v26, v26
    v_exp_f32 v27, v27
    v_exp_f32 v28, v28
    v_exp_f32 v29, v29
    v_exp_f32 v30, v30
    v_exp_f32 v31, v31
    s_setprio 1
    v_exp_f32 v0, v0
    v_exp_f32 v1, v1
    v_smfmac_f32_32x32x32_bf16 v[80:95], v[112:115], v[24:31], v116
    s_mov_b64 exec, s[48:49]
    ds_read_b128 v[112:115], v117 offset:44288
    s_mov_b64 exec, -1
    v_exp_f32 v2, v2
    v_exp_f32 v3, v3
    v_exp_f32 v4, v4
    v_mfma_f32_32x32x16_bf16 v[16:31], v[104:107], v[100:103], v[48:63]
    ds_read_b128 v[104:107], v117 offset:45056
    v_exp_f32 v5, v5
    v_exp_f32 v6, v6
    v_exp_f32 v7, v7
    v_exp_f32 v8, v8
    v_exp_f32 v9, v9
    s_waitcnt lgkmcnt(2)
    v_smfmac_f32_32x32x32_bf16 v[64:79], v[108:111], v[0:7], v116
    v_exp_f32 v10, v10
    v_exp_f32 v11, v11
    v_exp_f32 v12, v12
    buffer_load_dwordx4 v[156:159], v121, s[28:31], 0 offen offset:96
    v_exp_f32 v13, v13
    v_exp_f32 v14, v14
    v_exp_f32 v15, v15
    s_setprio 0
    v_exp_f32 v16, v16
    v_exp_f32 v17, v17
    s_waitcnt lgkmcnt(0)
    v_smfmac_f32_32x32x32_bf16 v[64:79], v[112:115], v[8:15], v116
    v_exp_f32 v18, v18
    v_exp_f32 v19, v19
    v_exp_f32 v20, v20
    v_mfma_f32_32x32x16_bf16 v[0:15], v[104:107], v[96:99], v[32:47]
    v_exp_f32 v21, v21
    v_exp_f32 v22, v22
    v_exp_f32 v23, v23
    v_exp_f32 v24, v24
    v_exp_f32 v25, v25
    v_smfmac_f32_32x32x32_bf16 v[80:95], v[108:111], v[16:23], v116
    s_mov_b64 exec, s[48:49]
    ds_read_b128 v[108:111], v117 offset:46080
    s_mov_b64 exec, -1
    v_exp_f32 v26, v26
    v_exp_f32 v27, v27
    v_exp_f32 v28, v28
    s_waitcnt vmcnt(3)
    v_cmp_ne_u32 vcc, s58, v160
    v_cmp_ne_u32 s[4:5], s58, v161
    v_cmp_ne_u32 s[6:7], s58, v162
    v_cmp_ne_u32 s[62:63], s58, v163
    s_or_b64 vcc, vcc, s[4:5]
    s_or_b64 s[6:7], s[6:7], s[62:63]
    s_or_b64 vcc, vcc, s[6:7]
    s_cbranch_vccnz L_at_fretry
L_at_fok:
    s_or_b32 s4, s2, s3
    s_cbranch_scc0 L_at_epoch
L_at_epochr:
    v_exp_f32 v29, v29
    v_exp_f32 v30, v30
    v_exp_f32 v31, v31
    s_setprio 3
    v_exp_f32 v0, v0
    v_exp_f32 v1, v1
    v_smfmac_f32_32x32x32_bf16 v[80:95], v[112:115], v[24:31], v116
    s_mov_b64 exec, s[48:49]
    ds_read_b128 v[112:115], v117 offset:46336
    s_mov_b64 exec, -1
    v_exp_f32 v2, v2
    v_exp_f32 v3, v3
    v_exp_f32 v4, v4
    v_mfma_f32_32x32x16_bf16 v[16:31], v[104:107], v[100:103], v[48:63]
    ds_read_b128 v[104:107], v117 offset:47104
    v_exp_f32 v5, v5
    v_exp_f32 v6, v6
    v_exp_f32 v7, v7
    v_exp_f32 v8, v8
    v_exp_f32 v9, v9
    s_waitcnt lgkmcnt(2)
    v_smfmac_f32_32x32x32_bf16 v[64:79], v[108:111], v[0:7], v116
    v_exp_f32 v10, v10
    v_exp_f32 v11, v11
    v_exp_f32 v12, v12
    buffer_load_dwordx4 v[160:163], v120, s[16:19], s85 offen offset:0 sc1
    buffer_load_dwordx4 v[164:167], v120, s[16:19], s85 offen offset:1024 sc1
    v_exp_f32 v13, v13
    v_exp_f32 v14, v14
    v_exp_f32 v15, v15
    s_setprio 2
    v_exp_f32 v16, v16
    v_exp_f32 v17, v17
    s_waitcnt lgkmcnt(0)
    v_smfmac_f32_32x32x32_bf16 v[64:79], v[112:115], v[8:15], v116
    v_exp_f32 v18, v18
    v_exp_f32 v19, v19
    v_exp_f32 v20, v20
    v_mfma_f32_32x32x16_bf16 v[0:15], v[104:107], v[96:99], v[32:47]
    v_exp_f32 v21, v21
    v_exp_f32 v22, v22
    v_exp_f32 v23, v23
    v_exp_f32 v24, v24
    v_exp_f32 v25, v25
    v_smfmac_f32_32x32x32_bf16 v[80:95], v[108:111], v[16:23], v116
    s_mov_b64 exec, s[48:49]
    ds_read_b128 v[108:111], v117 offset:48128
    s_mov_b64 exec, -1
    v_exp_f32 v26, v26
    v_exp_f32 v27, v27
    v_exp_f32 v28, v28
    buffer_load_dwordx4 v[168:171], v120, s[16:19], s85 offen offset:2048 sc1
    buffer_load_dwordx4 v[172:175], v120, s[16:19], s85 offen offset:3072 sc1
    v_exp_f32 v29, v29
    v_exp_f32 v30, v30
    v_exp_f32 v31, v31
    s_setprio 1
    v_exp_f32 v0, v0
    v_exp_f32 v1, v1
    v_smfmac_f32_32x32x32_bf16 v[80:95], v[112:115], v[24:31], v116
    s_mov_b64 exec, s[48:49]
    ds_read_b128 v[112:115], v117 offset:48384
    s_mov_b64 exec, -1
    v_exp_f32 v2, v2
    v_exp_f32 v3, v3
    v_exp_f32 v4, v4
    v_mfma_f32_32x32x16_bf16 v[16:31], v[104:107], v[100:103], v[48:63]
    ds_read_b128 v[104:107], v117 offset:49152
    v_exp_f32 v5, v5
    v_exp_f32 v6, v6
    v_exp_f32 v7, v7
    v_exp_f32 v8, v8
    v_exp_f32 v9, v9
    s_waitcnt lgkmcnt(2)
    v_smfmac_f32_32x32x32_bf16 v[64:79], v[108:111], v[0:7], v116
    v_exp_f32 v10, v10
    v_exp_f32 v11, v11
    v_exp_f32 v12, v12
    buffer_load_dwordx4 v[176:179], v120, s[16:19], s86 offen offset:0 sc1
    buffer_load_dwordx4 v[180:183], v120, s[16:19], s86 offen offset:1024 sc1
    v_exp_f32 v13, v13
    v_exp_f32 v14, v14
    v_exp_f32 v15, v15
    s_setprio 0
    v_exp_f32 v16, v16
    v_exp_f32 v17, v17
    s_waitcnt lgkmcnt(0)
    v_smfmac_f32_32x32x32_bf16 v[64:79], v[112:115], v[8:15], v116
    v_exp_f32 v18, v18
    v_exp_f32 v19, v19
    v_exp_f32 v20, v20
    v_mfma_f32_32x32x16_bf16 v[0:15], v[104:107], v[96:99], v[32:47]
    v_exp_f32 v21, v21
    v_exp_f32 v22, v22
    v_exp_f32 v23, v23
    v_exp_f32 v24, v24
    v_exp_f32 v25, v25
    v_smfmac_f32_32x32x32_bf16 v[80:95], v[108:111], v[16:23], v116
    s_mov_b64 exec, s[48:49]
    ds_read_b128 v[108:111], v117 offset:50176
    s_mov_b64 exec, -1
    v_exp_f32 v26, v26
    v_exp_f32 v27, v27
    v_exp_f32 v28, v28
    buffer_load_dwordx4 v[184:187], v120, s[16:19], s86 offen offset:2048 sc1
    buffer_load_dwordx4 v[188:191], v120, s[16:19], s86 offen offset:3072 sc1
    v_exp_f32 v29, v29
    v_exp_f32 v30, v30
    v_exp_f32 v31, v31
    s_setprio 3
    v_exp_f32 v0, v0
    v_exp_f32 v1, v1
    v_smfmac_f32_32x32x32_bf16 v[80:95], v[112:115], v[24:31], v116
    s_mov_b64 exec, s[48:49]
    ds_read_b128 v[112:115], v117 offset:50432
    s_mov_b64 exec, -1
    v_exp_f32 v2, v2
    v_exp_f32 v3, v3
    v_exp_f32 v4, v4
    v_mfma_f32_32x32x16_bf16 v[16:31], v[104:107], v[100:103], v[48:63]
    ds_read_b128 v[104:107], v117 offset:51200
    v_exp_f32 v5, v5
    v_exp_f32 v6, v6
    v_exp_f32 v7, v7
    v_exp_f32 v8, v8
    v_exp_f32 v9, v9
    s_waitcnt lgkmcnt(2)
    v_smfmac_f32_32x32x32_bf16 v[64:79], v[108:111], v[0:7], v116
    v_exp_f32 v10, v10
    v_exp_f32 v11, v11
    v_exp_f32 v12, v12
    buffer_load_dwordx4 v[192:195], v120, s[16:19], s87 offen offset:0 sc1
    buffer_load_dwordx4 v[196:199], v120, s[16:19], s87 offen offset:1024 sc1
    v_exp_f32 v13, v13
    v_exp_f32 v14, v14
    v_exp_f32 v15, v15
    s_setprio 2
    v_exp_f32 v16, v16
    v_exp_f32 v17, v17
    s_waitcnt lgkmcnt(0)
    v_smfmac_f32_32x32x32_bf16 v[64:79], v[112:115], v[8:15], v116
    v_exp_f32 v18, v18
    v_exp_f32 v19, v19
    v_exp_f32 v20, v20
    v_mfma_f32_32x32x16_bf16 v[0:15], v[104:107], v[96:99], v[32:47]
    v_exp_f32 v21, v21
    v_exp_f32 v22, v22
    v_exp_f32 v23, v23
    v_exp_f32 v24, v24
    v_exp_f32 v25, v25
    v_smfmac_f32_32x32x32_bf16 v[80:95], v[108:111], v[16:23], v116
    s_mov_b64 exec, s[48:49]
    ds_read_b128 v[108:111], v117 offset:52224
    s_mov_b64 exec, -1
    v_exp_f32 v26, v26
    v_exp_f32 v27, v27
    v_exp_f32 v28, v28
    buffer_load_dwordx4 v[200:203], v120, s[16:19], s87 offen offset:2048 sc1
    buffer_load_dwordx4 v[204:207], v120, s[16:19], s87 offen offset:3072 sc1
    v_exp_f32 v29, v29
    v_exp_f32 v30, v30
    v_exp_f32 v31, v31
    s_setprio 1
    v_exp_f32 v0, v0
    v_exp_f32 v1, v1
    v_smfmac_f32_32x32x32_bf16 v[80:95], v[112:115], v[24:31], v116
    s_mov_b64 exec, s[48:49]
    ds_read_b128 v[112:115], v117 offset:52480
    s_mov_b64 exec, -1
    v_exp_f32 v2, v2
    v_exp_f32 v3, v3
    v_exp_f32 v4, v4
    v_mfma_f32_32x32x16_bf16 v[16:31], v[104:107], v[100:103], v[48:63]
    ds_read_b128 v[104:107], v117 offset:53248
    v_exp_f32 v5, v5
    v_exp_f32 v6, v6
    v_exp_f32 v7, v7
    v_exp_f32 v8, v8
    v_exp_f32 v9, v9
    s_waitcnt lgkmcnt(2)
    v_smfmac_f32_32x32x32_bf16 v[64:79], v[108:111], v[0:7], v116
    v_exp_f32 v10, v10
    v_exp_f32 v11, v11
    v_exp_f32 v12, v12
    s_add_u32 s87, s87, 0x1000
    buffer_load_dwordx4 v[208:211], v120, s[16:19], s87 offen offset:0 sc1
    buffer_load_dwordx4 v[212:215], v120, s[16:19], s87 offen offset:1024 sc1
    v_exp_f32 v13, v13
    v_exp_f32 v14, v14
    v_exp_f32 v15, v15
    s_setprio 0
    v_exp_f32 v16, v16
    v_exp_f32 v17, v17
    s_waitcnt lgkmcnt(0)
    v_smfmac_f32_32x32x32_bf16 v[64:79], v[112:115], v[8:15], v116
    v_exp_f32 v18, v18
    v_exp_f32 v19, v19
    v_exp_f32 v20, v20
    v_mfma_f32_32x32x16_bf16 v[0:15], v[104:107], v[96:99], v[32:47]
    v_exp_f32 v21, v21
    v_exp_f32 v22, v22
    v_exp_f32 v23, v23
    v_exp_f32 v24, v24
    v_exp_f32 v25, v25
    v_smfmac_f32_32x32x32_bf16 v[80:95], v[108:111], v[16:23], v116
    s_mov_b64 exec, s[48:49]
    ds_read_b128 v[108:111], v117 offset:54272
    s_mov_b64 exec, -1
    v_exp_f32 v26, v26
    v_exp_f32 v27, v27
    v_exp_f32 v28, v28
    buffer_load_dwordx4 v[216:219], v120, s[16:19], s87 offen offset:2048 sc1
    buffer_load_dwordx4 v[220:223], v120, s[16:19], s87 offen offset:3072 sc1
    v_exp_f32 v29, v29
    v_exp_f32 v30, v30
    v_exp_f32 v31, v31
    s_setprio 3
    v_exp_f32 v0, v0
    v_exp_f32 v1, v1
    v_smfmac_f32_32x32x32_bf16 v[80:95], v[112:115], v[24:31], v116
    s_mov_b64 exec, s[48:49]
    ds_read_b128 v[112:115], v117 offset:54528
    s_mov_b64 exec, -1
    v_exp_f32 v2, v2
    v_exp_f32 v3, v3
    v_exp_f32 v4, v4
    v_mfma_f32_32x32x16_bf16 v[16:31], v[104:107], v[100:103], v[48:63]
    ds_read_b128 v[104:107], v117 offset:55296
    v_exp_f32 v5, v5
    v_exp_f32 v6, v6
    v_exp_f32 v7, v7
    v_exp_f32 v8, v8
    v_exp_f32 v9, v9
    s_waitcnt lgkmcnt(2)
    v_smfmac_f32_32x32x32_bf16 v[64:79], v[108:111], v[0:7], v116
    v_exp_f32 v10, v10
    v_exp_f32 v11, v11
    v_exp_f32 v12, v12
    s_add_u32 s87, s87, 0x1000
    buffer_load_dwordx4 v[224:227], v120, s[16:19], s87 offen offset:0 sc1
    buffer_load_dwordx4 v[228:231], v120, s[16:19], s87 offen offset:1024 sc1
    v_exp_f32 v13, v13
    v_exp_f32 v14, v14
    v_exp_f32 v15, v15
    s_setprio 2
    v_exp_f32 v16, v16
    v_exp_f32 v17, v17
    s_waitcnt lgkmcnt(0)
    v_smfmac_f32_32x32x32_bf16 v[64:79], v[112:115], v[8:15], v116
    v_exp_f32 v18, v18
    v_exp_f32 v19, v19
    v_exp_f32 v20, v20
    v_mfma_f32_32x32x16_bf16 v[0:15], v[104:107], v[96:99], v[32:47]
    v_exp_f32 v21, v21
    v_exp_f32 v22, v22
    v_exp_f32 v23, v23
    v_exp_f32 v24, v24
    v_exp_f32 v25, v25
    v_smfmac_f32_32x32x32_bf16 v[80:95], v[108:111], v[16:23], v116
    s_mov_b64 exec, s[48:49]
    ds_read_b128 v[108:111], v117 offset:56320
    s_mov_b64 exec, -1
    v_exp_f32 v26, v26
    v_exp_f32 v27, v27
    v_exp_f32 v28, v28
    buffer_load_dwordx4 v[232:235], v120, s[16:19], s87 offen offset:2048 sc1
    buffer_load_dwordx4 v[236:239], v120, s[16:19], s87 offen offset:3072 sc1
    v_exp_f32 v29, v29
    v_exp_f32 v30, v30
    v_exp_f32 v31, v31
    s_setprio 1
    v_exp_f32 v0, v0
    v_exp_f32 v1, v1
    v_smfmac_f32_32x32x32_bf16 v[80:95], v[112:115], v[24:31], v116
    s_mov_b64 exec, s[48:49]
    ds_read_b128 v[112:115], v117 offset:56576
    s_mov_b64 exec, -1
    v_exp_f32 v2, v2
    v_exp_f32 v3, v3
    v_exp_f32 v4, v4
    v_mfma_f32_32x32x16_bf16 v[16:31], v[104:107], v[100:103], v[48:63]
    ds_read_b128 v[104:107], v117 offset:57344
    v_exp_f32 v5, v5
    v_exp_f32 v6, v6
    v_exp_f32 v7, v7
    v_exp_f32 v8, v8
    v_exp_f32 v9, v9
    s_waitcnt lgkmcnt(2)
    v_smfmac_f32_32x32x32_bf16 v[64:79], v[108:111], v[0:7], v116
    v_exp_f32 v10, v10
    v_exp_f32 v11, v11
    v_exp_f32 v12, v12
    s_add_u32 s87, s87, 0x1000
    buffer_load_dwordx4 v[240:243], v120, s[16:19], s87 offen offset:0 sc1
    buffer_load_dwordx4 v[244:247], v120, s[16:19], s87 offen offset:1024 sc1
    v_exp_f32 v13, v13
    v_exp_f32 v14, v14
    v_exp_f32 v15, v15
    s_setprio 0
    v_exp_f32 v16, v16
    v_exp_f32 v17, v17
    s_waitcnt lgkmcnt(0)
    v_smfmac_f32_32x32x32_bf16 v[64:79], v[112:115], v[8:15], v116
    v_exp_f32 v18, v18
    v_exp_f32 v19, v19
    v_exp_f32 v20, v20
    v_mfma_f32_32x32x16_bf16 v[0:15], v[104:107], v[96:99], v[32:47]
    v_exp_f32 v21, v21
    v_exp_f32 v22, v22
    v_exp_f32 v23, v23
    v_exp_f32 v24, v24
    v_exp_f32 v25, v25
    v_smfmac_f32_32x32x32_bf16 v[80:95], v[108:111], v[16:23], v116
    s_mov_b64 exec, s[48:49]
    ds_read_b128 v[108:111], v117 offset:58368
    s_mov_b64 exec, -1
    v_exp_f32 v26, v26
    v_exp_f32 v27, v27
    v_exp_f32 v28, v28
    buffer_load_dwordx4 v[248:251], v120, s[16:19], s87 offen offset:2048 sc1
    buffer_load_dwordx4 v[252:255], v120, s[16:19], s87 offen offset:3072 sc1
    v_exp_f32 v29, v29
    v_exp_f32 v30, v30
    v_exp_f32 v31, v31
    s_setprio 3
    v_exp_f32 v0, v0
    v_exp_f32 v1, v1
    v_smfmac_f32_32x32x32_bf16 v[80:95], v[112:115], v[24:31], v116
    s_mov_b64 exec, s[48:49]
    ds_read_b128 v[112:115], v117 offset:58624
    s_mov_b64 exec, -1
    v_exp_f32 v2, v2
    v_exp_f32 v3, v3
    v_exp_f32 v4, v4
    v_mfma_f32_32x32x16_bf16 v[16:31], v[104:107], v[100:103], v[48:63]
    ds_read_b128 v[104:107], v117 offset:59392
    v_exp_f32 v5, v5
    v_exp_f32 v6, v6
    v_exp_f32 v7, v7
    v_exp_f32 v8, v8
    v_exp_f32 v9, v9
    s_waitcnt lgkmcnt(2)
    v_smfmac_f32_32x32x32_bf16 v[64:79], v[108:111], v[0:7], v116
    v_exp_f32 v10, v10
    v_exp_f32 v11, v11
    v_exp_f32 v12, v12
    v_and_b32 v123, 31, v122
    v_lshlrev_b32 v123, 2, v123
    v_mov_b32 v124, 0
    s_lshl_b32 s4, s77, 7
    s_lshl_b32 s5, s83, 10
    s_add_u32 s4, s4, s5
    s_add_u32 s4, s4, 9961472
    s_mov_b32 s5, 9962496
    buffer_load_dword v123, v123, s[16:19], s4 offen sc1
    buffer_load_dword v124, v124, s[16:19], s5 offen sc1
    v_exp_f32 v13, v13
    v_exp_f32 v14, v14
    v_exp_f32 v15, v15
    s_setprio 2
    v_exp_f32 v16, v16
    v_exp_f32 v17, v17
    s_waitcnt lgkmcnt(0)
    v_smfmac_f32_32x32x32_bf16 v[64:79], v[112:115], v[8:15], v116
    v_exp_f32 v18, v18
    v_exp_f32 v19, v19
    v_exp_f32 v20, v20
    v_mfma_f32_32x32x16_bf16 v[0:15], v[104:107], v[96:99], v[32:47]
    v_exp_f32 v21, v21
    v_exp_f32 v22, v22
    v_exp_f32 v23, v23
    v_exp_f32 v24, v24
    v_exp_f32 v25, v25
    v_smfmac_f32_32x32x32_bf16 v[80:95], v[108:111], v[16:23], v116
    s_mov_b64 exec, s[48:49]
    ds_read_b128 v[108:111], v117 offset:60416
    s_mov_b64 exec, -1
    v_exp_f32 v26, v26
    v_exp_f32 v27, v27
    v_exp_f32 v28, v28
    v_exp_f32 v29, v29
    v_exp_f32 v30, v30
    v_exp_f32 v31, v31
    s_setprio 1
    v_exp_f32 v0, v0
    v_exp_f32 v1, v1
    v_smfmac_f32_32x32x32_bf16 v[80:95], v[112:115], v[24:31], v116
    s_mov_b64 exec, s[48:49]
    ds_read_b128 v[112:115], v117 offset:60672
    s_mov_b64 exec, -1
    v_exp_f32 v2, v2
    v_exp_f32 v3, v3
    v_exp_f32 v4, v4
    v_mfma_f32_32x32x16_bf16 v[16:31], v[104:107], v[100:103], v[48:63]
    ds_read_b128 v[104:107], v117 offset:61440
    v_exp_f32 v5, v5
    v_exp_f32 v6, v6
    v_exp_f32 v7, v7
    v_exp_f32 v8, v8
    v_exp_f32 v9, v9
    s_waitcnt lgkmcnt(2)
    v_smfmac_f32_32x32x32_bf16 v[64:79], v[108:111], v[0:7], v116
    v_exp_f32 v10, v10
    v_exp_f32 v11, v11
    v_exp_f32 v12, v12
    v_exp_f32 v13, v13
    v_exp_f32 v14, v14
    v_exp_f32 v15, v15
    s_setprio 0
    v_exp_f32 v16, v16
    v_exp_f32 v17, v17
    s_waitcnt lgkmcnt(0)
    v_smfmac_f32_32x32x32_bf16 v[64:79], v[112:115], v[8:15], v116
    v_exp_f32 v18, v18
    v_exp_f32 v19, v19
    v_exp_f32 v20, v20
    v_mfma_f32_32x32x16_bf16 v[0:15], v[104:107], v[96:99], v[32:47]
    v_exp_f32 v21, v21
    v_exp_f32 v22, v22
    v_exp_f32 v23, v23
    v_exp_f32 v24, v24
    v_exp_f32 v25, v25
    v_smfmac_f32_32x32x32_bf16 v[80:95], v[108:111], v[16:23], v116
    s_mov_b64 exec, s[48:49]
    ds_read_b128 v[108:111], v117 offset:62464
    s_mov_b64 exec, -1
    v_exp_f32 v26, v26
    v_exp_f32 v27, v27
    v_exp_f32 v28, v28
    v_exp_f32 v29, v29
    v_exp_f32 v30, v30
    v_exp_f32 v31, v31
    s_setprio 3
    v_exp_f32 v0, v0
    v_exp_f32 v1, v1
    v_smfmac_f32_32x32x32_bf16 v[80:95], v[112:115], v[24:31], v116
    s_mov_b64 exec, s[48:49]
    ds_read_b128 v[112:115], v117 offset:62720
    s_mov_b64 exec, -1
    v_exp_f32 v2, v2
    v_exp_f32 v3, v3
    v_exp_f32 v4, v4
    v_mfma_f32_32x32x16_bf16 v[16:31], v[104:107], v[100:103], v[48:63]
    ds_read_b128 v[104:107], v117 offset:63488
    v_exp_f32 v5, v5
    v_exp_f32 v6, v6
    v_exp_f32 v7, v7
    v_exp_f32 v8, v8
    v_exp_f32 v9, v9
    s_waitcnt lgkmcnt(2)
    v_smfmac_f32_32x32x32_bf16 v[64:79], v[108:111], v[0:7], v116
    v_exp_f32 v10, v10
    v_exp_f32 v11, v11
    v_exp_f32 v12, v12
    s_waitcnt vmcnt(0)
    s_cmp_eq_u32 s76, 0
    s_cbranch_scc0 L_a2_nopatch
    s_mov_b32 exec_lo, 1
    s_mov_b32 exec_hi, 1
    v_mov_b32 v144, 0xbf803f80
    v_mov_b32 v145, 0xbf803f80
    v_mov_b32 v146, 0xbf803f80
    v_mov_b32 v147, 0xbf803f80
    v_mov_b32 v148, 0xbf803f80
    v_mov_b32 v149, 0xbf803f80
    v_mov_b32 v150, 0xbf803f80
    v_mov_b32 v151, 0xbf803f80
    v_mov_b32 v152, 0xbf803f80
    v_mov_b32 v153, 0xbf803f80
    v_mov_b32 v154, 0xbf803f80
    v_mov_b32 v155, 0xbf803f80
    v_mov_b32 v156, 0xbf803f80
    v_mov_b32 v157, 0xbf803f80
    v_mov_b32 v158, 0xbf803f80
    v_mov_b32 v159, 0xbf803f80
    s_mov_b64 exec, -1
L_a2_nopatch:
    v_exp_f32 v13, v13
    v_exp_f32 v14, v14
    v_exp_f32 v15, v15
    s_setprio 2
    v_exp_f32 v16, v16
    v_exp_f32 v17, v17
    s_waitcnt lgkmcnt(0)
    v_smfmac_f32_32x32x32_bf16 v[64:79], v[112:115], v[8:15], v116
    v_exp_f32 v18, v18
    v_exp_f32 v19, v19
    v_exp_f32 v20, v20
    v_mfma_f32_32x32x16_bf16 v[0:15], v[104:107], v[96:99], v[32:47]
    v_exp_f32 v21, v21
    v_exp_f32 v22, v22
    v_exp_f32 v23, v23
    v_exp_f32 v24, v24
    v_exp_f32 v25, v25
    v_smfmac_f32_32x32x32_bf16 v[80:95], v[108:111], v[16:23], v116
    s_mov_b64 exec, s[48:49]
    ds_read_b128 v[108:111], v117 offset:64512
    s_mov_b64 exec, -1
    v_exp_f32 v26, v26
    v_exp_f32 v27, v27
    v_exp_f32 v28, v28
    s_mul_i32 s4, s3, 2304
    s_add_u32 m0, s4, 32768
    s_xor_b32 s5, s3, 4
    s_mul_i32 s5, s5, 2304
    s_add_u32 s70, s5, 32768
    s_mov_b32 s71, 2071986176
    v_exp_f32 v29, v29
    v_exp_f32 v30, v30
    v_exp_f32 v31, v31
    s_setprio 1
    v_exp_f32 v0, v0
    v_exp_f32 v1, v1
    v_smfmac_f32_32x32x32_bf16 v[80:95], v[112:115], v[24:31], v116
    s_mov_b64 exec, s[48:49]
    ds_read_b128 v[112:115], v117 offset:64768
    s_mov_b64 exec, -1
    v_exp_f32 v2, v2
    v_exp_f32 v3, v3
    v_exp_f32 v4, v4
    v_mfma_f32_32x32x16_bf16 v[16:31], v[104:107], v[100:103], v[48:63]
    v_exp_f32 v5, v5
    v_exp_f32 v6, v6
    v_exp_f32 v7, v7
    v_mfma_f32_32x32x16_bf16 v[32:47], v[128:131], v[160:163], 0
    v_exp_f32 v8, v8
    v_exp_f32 v9, v9
    s_waitcnt lgkmcnt(1)
    v_smfmac_f32_32x32x32_bf16 v[64:79], v[108:111], v[0:7], v116
    v_exp_f32 v10, v10
    v_exp_f32 v11, v11
    v_exp_f32 v12, v12
    v_mfma_f32_32x32x16_bf16 v[32:47], v[132:135], v[164:167], v[32:47]
    v_exp_f32 v13, v13
    v_exp_f32 v14, v14
    v_exp_f32 v15, v15
    s_setprio 0
    v_exp_f32 v16, v16
    v_exp_f32 v17, v17
    s_waitcnt lgkmcnt(0)
    v_smfmac_f32_32x32x32_bf16 v[64:79], v[112:115], v[8:15], v116
    v_exp_f32 v18, v18
    v_exp_f32 v19, v19
    v_exp_f32 v20, v20
    v_mfma_f32_32x32x16_bf16 v[32:47], v[136:139], v[168:171], v[32:47]
    v_exp_f32 v21, v21
    v_exp_f32 v22, v22
    v_exp_f32 v23, v23
    v_mfma_f32_32x32x16_bf16 v[32:47], v[140:143], v[172:175], v[32:47]
    v_exp_f32 v24, v24
    v_exp_f32 v25, v25
    v_smfmac_f32_32x32x32_bf16 v[80:95], v[108:111], v[16:23], v116
    v_exp_f32 v26, v26
    v_exp_f32 v27, v27
    v_exp_f32 v28, v28
    v_mfma_f32_32x32x16_bf16 v[48:63], v[144:147], v[176:179], 0
    s_cmp_eq_u32 s79, 0
    v_exp_f32 v29, v29
    v_exp_f32 v30, v30
    v_exp_f32 v31, v31
    s_setprio 0
    s_cbranch_scc1 L_mg_k0
    v_smfmac_f32_32x32x32_bf16 v[80:95], v[112:115], v[24:31], v116
    ds_write_addtid_b32 v64 offset:32768
    ds_write_addtid_b32 v65 offset:33024
    ds_write_addtid_b32 v66 offset:33280
    ds_write_addtid_b32 v67 offset:33536
    ds_write_addtid_b32 v68 offset:33792
    ds_write_addtid_b32 v69 offset:34048
    ds_write_addtid_b32 v70 offset:34304
    ds_write_addtid_b32 v71 offset:34560
    ds_write_addtid_b32 v72 offset:34816
    v_mfma_f32_32x32x16_bf16 v[48:63], v[148:151], v[180:183], v[48:63]
    s_mov_b32 m0, s70
    s_waitcnt lgkmcnt(0)
    s_barrier
    ds_read_addtid_b32 v112 offset:34816
    ds_read_addtid_b32 v104 offset:32768
    ds_read_addtid_b32 v105 offset:33024
    ds_read_addtid_b32 v106 offset:33280
    ds_read_addtid_b32 v107 offset:33536
    ds_read_addtid_b32 v108 offset:33792
    ds_read_addtid_b32 v109 offset:34048
    ds_read_addtid_b32 v110 offset:34304
    ds_read_addtid_b32 v111 offset:34560
    v_mfma_f32_32x32x16_bf16 v[48:63], v[152:155], v[184:187], v[48:63]
    s_waitcnt lgkmcnt(8)
    v_add_f32 v112, v112, v88
    v_rcp_f32 v114, v112
    s_waitcnt lgkmcnt(6)
    v_pk_add_f32 v[104:105], v[104:105], v[80:81]
    s_waitcnt lgkmcnt(4)
    v_pk_add_f32 v[106:107], v[106:107], v[82:83]
    s_waitcnt lgkmcnt(2)
    v_pk_add_f32 v[108:109], v[108:109], v[84:85]
    s_waitcnt lgkmcnt(0)
    v_pk_add_f32 v[110:111], v[110:111], v[86:87]
    s_branch L_mg_j
L_mg_k0:
    v_smfmac_f32_32x32x32_bf16 v[80:95], v[112:115], v[24:31], v116
    s_nop 11
    ds_write_addtid_b32 v80 offset:32768
    ds_write_addtid_b32 v81 offset:33024
    ds_write_addtid_b32 v82 offset:33280
    ds_write_addtid_b32 v83 offset:33536
    ds_write_addtid_b32 v84 offset:33792
    ds_write_addtid_b32 v85 offset:34048
    ds_write_addtid_b32 v86 offset:34304
    ds_write_addtid_b32 v87 offset:34560
    ds_write_addtid_b32 v88 offset:34816
    v_mfma_f32_32x32x16_bf16 v[48:63], v[148:151], v[180:183], v[48:63]
    s_mov_b32 m0, s70
    s_waitcnt lgkmcnt(0)
    s_barrier
    ds_read_addtid_b32 v112 offset:34816
    ds_read_addtid_b32 v104 offset:32768
    ds_read_addtid_b32 v105 offset:33024
    ds_read_addtid_b32 v106 offset:33280
    ds_read_addtid_b32 v107 offset:33536
    ds_read_addtid_b32 v108 offset:33792
    ds_read_addtid_b32 v109 offset:34048
    ds_read_addtid_b32 v110 offset:34304
    ds_read_addtid_b32 v111 offset:34560
    v_mfma_f32_32x32x16_bf16 v[48:63], v[152:155], v[184:187], v[48:63]
    s_waitcnt lgkmcnt(8)
    v_add_f32 v112, v112, v72
    v_rcp_f32 v114, v112
    s_waitcnt lgkmcnt(6)
    v_pk_add_f32 v[104:105], v[104:105], v[64:65]
    s_waitcnt lgkmcnt(4)
    v_pk_add_f32 v[106:107], v[106:107], v[66:67]
    s_waitcnt lgkmcnt(2)
    v_pk_add_f32 v[108:109], v[108:109], v[68:69]
    s_waitcnt lgkmcnt(0)
    v_pk_add_f32 v[110:111], v[110:111], v[70:71]
L_mg_j:
    v_pk_mul_f32 v[104:105], v[104:105], v[114:115] op_sel_hi:[1,0]
    v_pk_mul_f32 v[106:107], v[106:107], v[114:115] op_sel_hi:[1,0]
    v_pk_mul_f32 v[108:109], v[108:109], v[114:115] op_sel_hi:[1,0]
    v_pk_mul_f32 v[110:111], v[110:111], v[114:115] op_sel_hi:[1,0]
    v_cvt_pk_bf16_f32 v80, v104, v105
    v_cvt_pk_bf16_f32 v81, v106, v107
    v_cvt_pk_bf16_f32 v82, v108, v109
    v_cvt_pk_bf16_f32 v83, v110, v111
    v_dot2c_f32_bf16 v112, v80, v80
    v_dot2c_f32_bf16 v112, v81, v81
    v_dot2c_f32_bf16 v112, v82, v82
    v_dot2c_f32_bf16 v112, v83, v83
    v_mfma_f32_32x32x16_bf16 v[48:63], v[156:159], v[188:191], v[48:63]
    s_nop 1
    v_cmp_ngt_f32 vcc, s71, v112
    s_cbranch_vccnz L_fallback
L_at_final:
    buffer_store_dwordx4 v[80:83], v120, s[16:19], s82 offen sc1
    s_lshl_b32 s4, s3, 13
    v_add_u32 v64, s4, v120
    s_mul_i32 s73, s76, s77
    s_lshl_b32 s4, s80, 15
    s_lshl_b32 s5, s3, 12
    s_add_u32 s70, s4, s5
    s_add_u32 s70, s70, 7340032
    s_add_u32 s5, s5, 98304
    s_mov_b32 m0, s5
    v_add_u32 v111, s5, v120
    s_cmp_eq_u32 s73, 0
    s_cbranch_scc1 L_a2_x
    ds_write_b128 v64, v[32:35] offset:0
    s_lshl_b32 s4, s3, 7
    s_add_u32 s4, s4, 90112
    v_lshl_add_u32 v66, v122, 2, s4
    v_lshrrev_b32 v67, 5, v122
    v_and_b32 v71, 31, v122
    s_lshl_b32 s6, s3, 9
    v_lshl_add_u32 v96, v71, 4, s6
    v_lshl_add_u32 v96, v67, 12, v96
    ds_write_b128 v64, v[36:39] offset:1024
    s_lshl_b32 s6, s3, 2
    v_lshl_add_u32 v73, v67, 1, s6
    v_lshlrev_b32 v97, 2, v73
    v_add_u32 v97, 90112, v97
    v_lshlrev_b32 v98, 2, v71
    v_add_u32 v98, 91136, v98
    s_lshl_b32 s4, s80, 5
    v_add_u32 v110, s4, v71
    ds_write_b128 v64, v[40:43] offset:2048
    v_lshlrev_b32 v110, 11, v110
    v_lshl_add_u32 v110, v67, 4, v110
    s_lshl_b32 s4, s77, 5
    v_add_u32 v71, s4, v71
    v_lshl_add_u32 v73, v73, 1, s84
    v_cmp_eq_u32 s[74:75], 0, v73
    v_cmp_eq_u32 s[64:65], 0, v71
    v_sub_u32 v84, 0x800, v73
    ds_write_b128 v64, v[44:47] offset:3072
    v_mov_b32 v85, 0x400
    v_cndmask_b32 v85, v84, v85, s[74:75]
    v_subrev_u32 v84, 2, v84
    v_sub_u32 v86, 0x200, v71
    v_mov_b32 v87, 0x100
    v_cndmask_b32 v86, v86, v87, s[64:65]
    v_lshlrev_b32 v87, 1, v71
    v_lshlrev_b32 v86, 1, v86
    ds_write_b128 v64, v[48:51] offset:4096
    v_lshl_add_u32 v100, v73, 11, v87
    v_lshl_add_u32 v101, v73, 11, v86
    v_lshl_add_u32 v102, v85, 11, v87
    v_lshl_add_u32 v103, v85, 11, v86
    v_lshl_add_u32 v104, v84, 11, v87
    v_lshl_add_u32 v105, v84, 11, v86
    s_cmp_eq_u32 s83, 0
    s_cselect_b64 vcc, -1, 0
    ds_write_b128 v64, v[52:55] offset:5120
    v_cndmask_b32 v106, 0, v123, vcc
    v_cndmask_b32 v107, 0, v124, vcc
    v_cndmask_b32 v108, v123, 0, vcc
    s_or_b64 s[66:67], s[74:75], s[64:65]
    s_and_b64 s[68:69], s[74:75], s[64:65]
    s_mov_b32 s71, 4096
    v_lshrrev_b32 v65, 4, v122
    v_and_b32 v88, 15, v122
    ds_write_b128 v64, v[56:59] offset:6144
    v_lshlrev_b32 v88, 4, v88
    v_lshl_add_u32 v109, v65, 9, v88
    v_add_u32 v109, 98304, v109
    s_lshl_b32 s4, s81, 8
    s_lshl_b32 s5, s3, 5
    s_add_u32 s72, s4, s5
    s_add_u32 s72, s72, 1024
    s_mov_b32 s5, 400000
    ds_write_b128 v64, v[60:63] offset:7168
L_a2_xr:
    s_cmp_eq_u32 s73, 0
    s_waitcnt lgkmcnt(0)
    s_barrier
    ds_read_b128 v[128:131], v96 offset:0
    ds_read_b128 v[132:135], v96 offset:8192
    ds_read_b128 v[136:139], v96 offset:16384
    ds_read_b128 v[140:143], v96 offset:24576
    ds_read_b128 v[144:147], v96 offset:32768
    ds_read_b128 v[148:151], v96 offset:40960
    ds_read_b128 v[152:155], v96 offset:49152
    ds_read_b128 v[156:159], v96 offset:57344
    buffer_load_dwordx4 v120, s[16:19], s70 offen offset:0 sc1 lds
    buffer_load_dwordx4 v120, s[16:19], s70 offen offset:1024 sc1 lds
    buffer_load_dwordx4 v120, s[16:19], s70 offen offset:2048 sc1 lds
    buffer_load_dwordx4 v120, s[16:19], s70 offen offset:3072 sc1 lds
    s_cbranch_scc0 L_a2_nox3
    ds_read_b64 v[160:161], v97 offset:0
    ds_read_b32 v176, v98 offset:0
    ds_read_b64 v[162:163], v97 offset:128
    ds_read_b32 v177, v98 offset:128
    ds_read_b64 v[164:165], v97 offset:256
    ds_read_b32 v178, v98 offset:256
    ds_read_b64 v[166:167], v97 offset:384
    ds_read_b32 v179, v98 offset:384
    ds_read_b64 v[168:169], v97 offset:512
    ds_read_b32 v180, v98 offset:512
    ds_read_b64 v[170:171], v97 offset:640
    ds_read_b32 v181, v98 offset:640
    ds_read_b64 v[172:173], v97 offset:768
    ds_read_b32 v182, v98 offset:768
    ds_read_b64 v[174:175], v97 offset:896
    ds_read_b32 v183, v98 offset:896
L_a2_nox3:
    s_waitcnt lgkmcnt(0)
    v_pk_add_f32 v[128:129], v[128:129], v[144:145]
    v_pk_add_f32 v[130:131], v[130:131], v[146:147]
    v_pk_add_f32 v[132:133], v[132:133], v[148:149]
    v_pk_add_f32 v[134:135], v[134:135], v[150:151]
    v_pk_add_f32 v[136:137], v[136:137], v[152:153]
    v_pk_add_f32 v[138:139], v[138:139], v[154:155]
    v_pk_add_f32 v[140:141], v[140:141], v[156:157]
    v_pk_add_f32 v[142:143], v[142:143], v[158:159]
    v_pk_add_f32 v[128:129], v[128:129], v[136:137]
    v_pk_add_f32 v[130:131], v[130:131], v[138:139]
    v_pk_add_f32 v[132:133], v[132:133], v[140:141]
    v_pk_add_f32 v[134:135], v[134:135], v[142:143]
    v_pk_add_f32 v[128:129], v[128:129], v[132:133]
    v_pk_add_f32 v[130:131], v[130:131], v[134:135]
    s_cbranch_scc0 L_a2_nox4
    v_pk_add_f32 v[160:161], v[160:161], v[168:169]
    v_add_f32 v176, v176, v180
    v_pk_add_f32 v[162:163], v[162:163], v[170:171]
    v_add_f32 v177, v177, v181
    v_pk_add_f32 v[164:165], v[164:165], v[172:173]
    v_add_f32 v178, v178, v182
    v_pk_add_f32 v[166:167], v[166:167], v[174:175]
    v_add_f32 v179, v179, v183
    v_pk_add_f32 v[160:161], v[160:161], v[164:165]
    v_add_f32 v176, v176, v178
    v_pk_add_f32 v[162:163], v[162:163], v[166:167]
    v_add_f32 v177, v177, v179
    v_pk_add_f32 v[160:161], v[160:161], v[162:163]
    v_add_f32 v176, v176, v177
    v_add_f32 v160, v160, v107
    v_sub_f32 v161, v161, v107
    v_add_f32 v176, v176, v106
L_a2_nox4:
    s_nop 0
    v_permlane32_swap_b32 v128, v130
    v_permlane32_swap_b32 v129, v131
    v_add_f32 v128, v128, v106
    v_sub_f32 v129, v129, v106
    v_add_f32 v177, v130, v107
    v_sub_f32 v130, v130, v108
    v_add_f32 v131, v131, v108
    v_cndmask_b32 v130, v130, 0, s[66:67]
    v_cndmask_b32 v131, v131, 0, s[64:65]
    v_sub_f32 v132, v128, v130
    v_sub_f32 v134, v129, v131
    v_add_f32 v133, v128, v130
    v_add_f32 v135, v129, v131
    v_cvt_pk_bf16_f32 v144, v132, v134
    buffer_store_short v144, v100, s[20:23], 0 offen
    v_cndmask_b32 v136, v133, v160, s[64:65]
    buffer_store_short_d16_hi v144, v100, s[20:23], s71 offen
    v_cndmask_b32 v139, v135, v161, s[64:65]
    v_cvt_pk_bf16_f32 v145, v136, v139
    v_cndmask_b32 v137, v133, v176, s[74:75]
    buffer_store_short v145, v101, s[20:23], 0 offen
    v_cvt_pk_bf16_f32 v146, v137, v135
    buffer_store_short_d16_hi v145, v101, s[20:23], s71 offen
    v_cndmask_b32 v138, v132, v160, s[64:65]
    buffer_store_short v146, v102, s[20:23], 0 offen
    v_cndmask_b32 v138, v138, v176, s[74:75]
    buffer_store_short_d16_hi v146, v104, s[20:23], 0 offen
    v_cndmask_b32 v138, v138, v177, s[68:69]
    v_cndmask_b32 v140, v134, v161, s[64:65]
    v_cvt_pk_bf16_f32 v147, v138, v140
    buffer_store_short v147, v103, s[20:23], 0 offen
    buffer_store_short_d16_hi v147, v105, s[20:23], 0 offen
    s_waitcnt vmcnt(8)
L_op_chk:
    ds_read_b128 v[48:51], v111 offset:0
    ds_read_b128 v[52:55], v111 offset:1024
    ds_read_b128 v[56:59], v111 offset:2048
    ds_read_b128 v[60:63], v111 offset:3072
    s_waitcnt lgkmcnt(3)
    v_max3_u32 v84, v48, v49, v50
    s_waitcnt lgkmcnt(2)
    v_max3_u32 v84, v84, v51, v52
    v_max3_u32 v84, v84, v53, v54
    s_waitcnt lgkmcnt(1)
    v_max3_u32 v84, v84, v55, v56
    v_max3_u32 v84, v84, v57, v58
    s_waitcnt lgkmcnt(0)
    v_max3_u32 v84, v84, v59, v60
    v_max3_u32 v84, v84, v61, v62
    v_max_u32 v84, v84, v63
    v_cmp_eq_u32 vcc, -1, v84
    s_cbranch_vccnz L_op_retry
L_op_ok:
    s_barrier
    ds_read_b128 v[0:3], v109 offset:0
    ds_read_b128 v[4:7], v109 offset:256
    ds_read_b128 v[8:11], v109 offset:2048
    ds_read_b128 v[12:15], v109 offset:2304
    ds_read_b128 v[16:19], v109 offset:4096
    ds_read_b128 v[20:23], v109 offset:4352
    ds_read_b128 v[24:27], v109 offset:6144
    ds_read_b128 v[28:31], v109 offset:6400
    ds_read_b128 v[32:35], v109 offset:8192
    ds_read_b128 v[36:39], v109 offset:8448
    ds_read_b128 v[40:43], v109 offset:10240
    s_waitcnt lgkmcnt(10)
    v_mfma_f32_16x16x32_bf16 v[72:75], v[192:195], v[0:3], 0
    ds_read_b128 v[44:47], v109 offset:10496
    s_waitcnt lgkmcnt(10)
    v_mfma_f32_16x16x32_bf16 v[76:79], v[192:195], v[4:7], 0
    ds_read_b128 v[0:3], v109 offset:12288
    s_waitcnt lgkmcnt(10)
    v_mfma_f32_16x16x32_bf16 v[72:75], v[196:199], v[8:11], v[72:75]
    ds_read_b128 v[4:7], v109 offset:12544
    s_waitcnt lgkmcnt(10)
    v_mfma_f32_16x16x32_bf16 v[76:79], v[196:199], v[12:15], v[76:79]
    ds_read_b128 v[8:11], v109 offset:14336
    s_waitcnt lgkmcnt(10)
    v_mfma_f32_16x16x32_bf16 v[72:75], v[200:203], v[16:19], v[72:75]
    ds_read_b128 v[12:15], v109 offset:14592
    s_waitcnt lgkmcnt(10)
    v_mfma_f32_16x16x32_bf16 v[76:79], v[200:203], v[20:23], v[76:79]
    ds_read_b128 v[16:19], v109 offset:16384
    s_waitcnt lgkmcnt(10)
    v_mfma_f32_16x16x32_bf16 v[72:75], v[204:207], v[24:27], v[72:75]
    ds_read_b128 v[20:23], v109 offset:16640
    s_waitcnt lgkmcnt(10)
    v_mfma_f32_16x16x32_bf16 v[76:79], v[204:207], v[28:31], v[76:79]
    ds_read_b128 v[24:27], v109 offset:18432
    s_waitcnt lgkmcnt(10)
    v_mfma_f32_16x16x32_bf16 v[72:75], v[208:211], v[32:35], v[72:75]
    ds_read_b128 v[28:31], v109 offset:18688
    s_waitcnt lgkmcnt(10)
    v_mfma_f32_16x16x32_bf16 v[76:79], v[208:211], v[36:39], v[76:79]
    ds_read_b128 v[32:35], v109 offset:20480
    s_waitcnt lgkmcnt(10)
    v_mfma_f32_16x16x32_bf16 v[72:75], v[212:215], v[40:43], v[72:75]
    ds_read_b128 v[36:39], v109 offset:20736
    s_waitcnt lgkmcnt(10)
    v_mfma_f32_16x16x32_bf16 v[76:79], v[212:215], v[44:47], v[76:79]
    ds_read_b128 v[40:43], v109 offset:22528
    s_waitcnt lgkmcnt(10)
    v_mfma_f32_16x16x32_bf16 v[72:75], v[216:219], v[0:3], v[72:75]
    ds_read_b128 v[44:47], v109 offset:22784
    s_waitcnt lgkmcnt(10)
    v_mfma_f32_16x16x32_bf16 v[76:79], v[216:219], v[4:7], v[76:79]
    ds_read_b128 v[0:3], v109 offset:24576
    s_waitcnt lgkmcnt(10)
    v_mfma_f32_16x16x32_bf16 v[72:75], v[220:223], v[8:11], v[72:75]
    ds_read_b128 v[4:7], v109 offset:24832
    s_waitcnt lgkmcnt(10)
    v_mfma_f32_16x16x32_bf16 v[76:79], v[220:223], v[12:15], v[76:79]
    ds_read_b128 v[8:11], v109 offset:26624
    s_waitcnt lgkmcnt(10)
    v_mfma_f32_16x16x32_bf16 v[72:75], v[224:227], v[16:19], v[72:75]
    ds_read_b128 v[12:15], v109 offset:26880
    s_waitcnt lgkmcnt(10)
    v_mfma_f32_16x16x32_bf16 v[76:79], v[224:227], v[20:23], v[76:79]
    ds_read_b128 v[16:19], v109 offset:28672
    s_waitcnt lgkmcnt(10)
    v_mfma_f32_16x16x32_bf16 v[72:75], v[228:231], v[24:27], v[72:75]
    ds_read_b128 v[20:23], v109 offset:28928
    s_waitcnt lgkmcnt(10)
    v_mfma_f32_16x16x32_bf16 v[76:79], v[228:231], v[28:31], v[76:79]
    ds_read_b128 v[24:27], v109 offset:30720
    s_waitcnt lgkmcnt(10)
    v_mfma_f32_16x16x32_bf16 v[72:75], v[232:235], v[32:35], v[72:75]
    ds_read_b128 v[28:31], v109 offset:30976
    s_waitcnt lgkmcnt(10)
    v_mfma_f32_16x16x32_bf16 v[76:79], v[232:235], v[36:39], v[76:79]
    s_waitcnt lgkmcnt(9)
    v_mfma_f32_16x16x32_bf16 v[72:75], v[236:239], v[40:43], v[72:75]
    s_waitcnt lgkmcnt(8)
    v_mfma_f32_16x16x32_bf16 v[76:79], v[236:239], v[44:47], v[76:79]
    s_waitcnt lgkmcnt(7)
    v_mfma_f32_16x16x32_bf16 v[72:75], v[240:243], v[0:3], v[72:75]
    s_waitcnt lgkmcnt(6)
    v_mfma_f32_16x16x32_bf16 v[76:79], v[240:243], v[4:7], v[76:79]
    s_waitcnt lgkmcnt(5)
    v_mfma_f32_16x16x32_bf16 v[72:75], v[244:247], v[8:11], v[72:75]
    s_waitcnt lgkmcnt(4)
    v_mfma_f32_16x16x32_bf16 v[76:79], v[244:247], v[12:15], v[76:79]
    s_waitcnt lgkmcnt(3)
    v_mfma_f32_16x16x32_bf16 v[72:75], v[248:251], v[16:19], v[72:75]
    s_waitcnt lgkmcnt(2)
    v_mfma_f32_16x16x32_bf16 v[76:79], v[248:251], v[20:23], v[76:79]
    s_waitcnt lgkmcnt(1)
    v_mfma_f32_16x16x32_bf16 v[72:75], v[252:255], v[24:27], v[72:75]
    s_waitcnt lgkmcnt(0)
    v_mfma_f32_16x16x32_bf16 v[76:79], v[252:255], v[28:31], v[76:79]
    s_nop 7
    v_cvt_pk_bf16_f32 v80, v72, v73
    v_cvt_pk_bf16_f32 v81, v74, v75
    v_cvt_pk_bf16_f32 v82, v76, v77
    v_cvt_pk_bf16_f32 v83, v78, v79
    s_nop 1
    v_permlane16_swap_b32 v80, v82
    v_permlane16_swap_b32 v81, v83
    buffer_store_dwordx4 v[80:83], v110, s[20:23], s72 offen
L_end:
    s_endpgm
L_op_retry:
    s_sub_u32 s5, s5, 1
    s_cbranch_scc1 L_op_ok
    buffer_load_dwordx4 v120, s[16:19], s70 offen offset:0 sc1 lds
    buffer_load_dwordx4 v120, s[16:19], s70 offen offset:1024 sc1 lds
    buffer_load_dwordx4 v120, s[16:19], s70 offen offset:2048 sc1 lds
    buffer_load_dwordx4 v120, s[16:19], s70 offen offset:3072 sc1 lds
    s_waitcnt vmcnt(0)
    s_branch L_op_chk
L_a2_x:
    v_mfma_f32_32x32x16_bf16 v[0:15], v[176:179], v[128:131], 0
    ds_write_b128 v64, v[32:35] offset:0
    v_mfma_f32_32x32x16_bf16 v[16:31], v[144:147], v[160:163], 0
    s_lshl_b32 s4, s3, 7
    s_add_u32 s4, s4, 90112
    v_lshl_add_u32 v66, v122, 2, s4
    v_lshrrev_b32 v67, 5, v122
    v_and_b32 v71, 31, v122
    s_lshl_b32 s6, s3, 9
    v_lshl_add_u32 v96, v71, 4, s6
    v_lshl_add_u32 v96, v67, 12, v96
    ds_write_b128 v64, v[36:39] offset:1024
    v_mfma_f32_32x32x16_bf16 v[0:15], v[180:183], v[132:135], v[0:15]
    s_lshl_b32 s6, s3, 2
    v_lshl_add_u32 v73, v67, 1, s6
    v_lshlrev_b32 v97, 2, v73
    v_add_u32 v97, 90112, v97
    v_lshlrev_b32 v98, 2, v71
    v_add_u32 v98, 91136, v98
    s_lshl_b32 s4, s80, 5
    v_add_u32 v110, s4, v71
    ds_write_b128 v64, v[40:43] offset:2048
    v_mfma_f32_32x32x16_bf16 v[16:31], v[148:151], v[164:167], v[16:31]
    v_lshlrev_b32 v110, 11, v110
    v_lshl_add_u32 v110, v67, 4, v110
    s_lshl_b32 s4, s77, 5
    v_add_u32 v71, s4, v71
    v_lshl_add_u32 v73, v73, 1, s84
    v_cmp_eq_u32 s[74:75], 0, v73
    v_cmp_eq_u32 s[64:65], 0, v71
    v_sub_u32 v84, 0x800, v73
    ds_write_b128 v64, v[44:47] offset:3072
    v_mfma_f32_32x32x16_bf16 v[0:15], v[184:187], v[136:139], v[0:15]
    v_mov_b32 v85, 0x400
    v_cndmask_b32 v85, v84, v85, s[74:75]
    v_subrev_u32 v84, 2, v84
    v_sub_u32 v86, 0x200, v71
    v_mov_b32 v87, 0x100
    v_cndmask_b32 v86, v86, v87, s[64:65]
    v_lshlrev_b32 v87, 1, v71
    v_lshlrev_b32 v86, 1, v86
    ds_write_b128 v64, v[48:51] offset:4096
    v_mfma_f32_32x32x16_bf16 v[16:31], v[152:155], v[168:171], v[16:31]
    v_lshl_add_u32 v100, v73, 11, v87
    v_lshl_add_u32 v101, v73, 11, v86
    v_lshl_add_u32 v102, v85, 11, v87
    v_lshl_add_u32 v103, v85, 11, v86
    v_lshl_add_u32 v104, v84, 11, v87
    v_lshl_add_u32 v105, v84, 11, v86
    s_cmp_eq_u32 s83, 0
    s_cselect_b64 vcc, -1, 0
    ds_write_b128 v64, v[52:55] offset:5120
    v_mfma_f32_32x32x16_bf16 v[0:15], v[188:191], v[140:143], v[0:15]
    v_cndmask_b32 v106, 0, v123, vcc
    v_cndmask_b32 v107, 0, v124, vcc
    v_cndmask_b32 v108, v123, 0, vcc
    s_or_b64 s[66:67], s[74:75], s[64:65]
    s_and_b64 s[68:69], s[74:75], s[64:65]
    s_mov_b32 s71, 4096
    v_lshrrev_b32 v65, 4, v122
    v_and_b32 v88, 15, v122
    ds_write_b128 v64, v[56:59] offset:6144
    v_mfma_f32_32x32x16_bf16 v[16:31], v[156:159], v[172:175], v[16:31]
    v_lshlrev_b32 v88, 4, v88
    v_lshl_add_u32 v109, v65, 9, v88
    v_add_u32 v109, 98304, v109
    s_lshl_b32 s4, s81, 8
    s_lshl_b32 s5, s3, 5
    s_add_u32 s72, s4, s5
    s_add_u32 s72, s72, 1024
    s_mov_b32 s5, 400000
    ds_write_b128 v64, v[60:63] offset:7168
    s_mov_b32 exec_hi, 0
    s_nop 7
    ds_write_b32 v66, v0
    ds_write_b32 v66, v16 offset:1024
    s_mov_b32 exec_hi, -1
    s_branch L_a2_xr
L_at_a1s0:
    buffer_store_dwordx4 v[192:195], v120, s[16:19], s73 offen sc1
    buffer_store_dwordx4 v[196:199], v120, s[16:19], s74 offen sc1
    s_add_u32 s73, s73, 0x8000
    s_add_u32 s74, s74, 0x8000
    s_branch L_at_a1r0
L_at_a1s1:
    buffer_store_dwordx4 v[200:203], v120, s[16:19], s73 offen sc1
    buffer_store_dwordx4 v[204:207], v120, s[16:19], s74 offen sc1
    s_branch L_at_a1r1
L_at_a1s2:
    buffer_store_dwordx4 v[208:211], v120, s[16:19], s92 offen sc1
    s_add_u32 s92, s92, 0x4000
    buffer_store_dwordx4 v[212:215], v120, s[16:19], s92 offen sc1
    s_branch L_at_a1r2
L_at_a1s3:
    buffer_store_dword v216, v224, s[16:19], 0 offen offset:0 sc1
    buffer_store_dword v217, v224, s[16:19], 0 offen offset:64 sc1
    s_branch L_at_a1r3
L_at_a1s4:
    buffer_store_dword v218, v224, s[16:19], 0 offen offset:128 sc1
    buffer_store_dword v219, v224, s[16:19], 0 offen offset:192 sc1
    s_branch L_at_a1r4
L_at_cnt1:
    s_waitcnt vmcnt(0)
    v_mov_b32 v123, 161792
    v_mov_b32 v124, 1
    s_mov_b64 exec, 1
    ds_add_rtn_u32 v124, v123, v124
    s_mov_b64 exec, -1
    s_branch L_at_cnt1r
L_at_pub1:
    v_readfirstlane_b32 s4, v124
    v_mov_b32 v123, s58
    s_cmp_eq_u32 s4, 3
    s_cbranch_scc0 L_at_pub1r
    v_lshlrev_b32 v124, 11, v122
    s_mov_b32 exec_hi, 0
    buffer_store_dword v123, v124, s[16:19], s14 offen sc1
    s_mov_b32 exec_hi, -1
    s_branch L_at_pub1r
L_at_pub2:
    v_mov_b32 v123, s58
    s_mov_b64 exec, 1
    buffer_store_dword v123, v120, s[16:19], s93 offen sc1
    s_mov_b64 exec, -1
    s_branch L_at_pub2r
L_at_epoch:
    s_mov_b32 s4, 10092544
    s_mov_b64 exec, 1
    buffer_store_dword v160, v120, s[16:19], s4 offen sc1
    s_mov_b64 exec, -1
    s_branch L_at_epochr
L_at_f1retry:
    s_mov_b32 s5, 400000
L_at_f1retry2:
    buffer_load_dword v123, v125, s[16:19], s15 offen offset:512 sc1
    s_waitcnt vmcnt(0)
    v_cmp_ne_u32 vcc, s58, v123
    s_cbranch_vccz L_at_f1ok
    s_sub_u32 s5, s5, 1
    s_cbranch_scc0 L_at_f1retry2
    s_branch L_at_f1ok
L_at_fretry:
    s_mov_b32 s93, 400000
L_at_fretry2:
    buffer_load_dword v160, v120, s[16:19], s92 offen offset:0 sc1
    buffer_load_dword v161, v120, s[16:19], s92 offen offset:1024 sc1
    buffer_load_dword v162, v120, s[16:19], s92 offen offset:2048 sc1
    buffer_load_dword v163, v120, s[16:19], s92 offen offset:3072 sc1
    s_waitcnt vmcnt(0)
    v_cmp_ne_u32 vcc, s58, v160
    v_cmp_ne_u32 s[4:5], s58, v161
    v_cmp_ne_u32 s[6:7], s58, v162
    v_cmp_ne_u32 s[62:63], s58, v163
    s_or_b64 vcc, vcc, s[4:5]
    s_or_b64 s[6:7], s[6:7], s[62:63]
    s_or_b64 vcc, vcc, s[6:7]
    s_cbranch_vccz L_at_fok
    s_sub_u32 s93, s93, 1
    s_cbranch_scc0 L_at_fretry2
    s_branch L_at_fok
L_fallback:
    s_cmp_eq_u32 s79, 0
    s_cbranch_scc1 L_fb_q
    v_mov_b64 v[96:97], v[100:101]
    v_mov_b64 v[98:99], v[102:103]
L_fb_q:
    v_mov_b32 v16, 0xff800000
    s_mov_b32 s4, s88
    s_mov_b32 s5, 64
L_fb_max:
    buffer_load_dwordx4 v[104:107], v120, s[16:19], s4 offen sc1
    s_waitcnt vmcnt(0)
    v_mfma_f32_32x32x16_bf16 v[0:15], v[104:107], v[96:99], 0
    s_nop 11
    v_max3_f32 v16, v16, v0, v1
    v_max3_f32 v16, v16, v2, v3
    v_max3_f32 v16, v16, v4, v5
    v_max3_f32 v16, v16, v6, v7
    v_max3_f32 v16, v16, v8, v9
    v_max3_f32 v16, v16, v10, v11
    v_max3_f32 v16, v16, v12, v13
    v_max3_f32 v16, v16, v14, v15
    s_add_u32 s4, s4, 2048
    s_sub_u32 s5, s5, 1
    s_cmp_lg_u32 s5, 0
    s_cbranch_scc1 L_fb_max
    v_mov_b32 v17, v16
    s_nop 1
    v_permlane32_swap_b32 v16, v17
    v_max_f32 v16, v16, v17
    v_sub_f32 v16, 3256877056, v16
    v_mov_b32 v17, v16
    v_mov_b32 v18, v16
    v_mov_b32 v19, v16
    v_mov_b32 v20, v16
    v_mov_b32 v21, v16
    v_mov_b32 v22, v16
    v_mov_b32 v23, v16
    v_mov_b32 v24, v16
    v_mov_b32 v25, v16
    v_mov_b32 v26, v16
    v_mov_b32 v27, v16
    v_mov_b32 v28, v16
    v_mov_b32 v29, v16
    v_mov_b32 v30, v16
    v_mov_b32 v31, v16
    v_mov_b32 v64, 0
    v_mov_b32 v65, 0
    v_mov_b32 v66, 0
    v_mov_b32 v67, 0
    v_mov_b32 v68, 0
    v_mov_b32 v69, 0
    v_mov_b32 v70, 0
    v_mov_b32 v71, 0
    v_mov_b32 v72, 0
    v_mov_b32 v73, 0
    v_mov_b32 v74, 0
    v_mov_b32 v75, 0
    v_mov_b32 v76, 0
    v_mov_b32 v77, 0
    v_mov_b32 v78, 0
    v_mov_b32 v79, 0
    v_mov_b32 v108, 1400918912
    v_mov_b32 v109, 1400918912
    v_mov_b32 v110, 1400918912
    v_mov_b32 v111, 1400918912
    v_mov_b32 v112, 1400918912
    v_mov_b32 v113, 1400918912
    v_mov_b32 v114, 1400918912
    v_mov_b32 v115, 1400918912
    s_mov_b32 s4, s88
    s_mov_b32 s5, 64
    s_mov_b32 s6, 0xffff
    s_mov_b32 s7, 0xffff
L_fb_pv:
    buffer_load_dwordx4 v[104:107], v120, s[16:19], s4 offen sc1
    s_mov_b64 exec, s[6:7]
    buffer_load_dwordx4 v[108:111], v120, s[16:19], s4 offen offset:1024 sc1
    buffer_load_dwordx4 v[112:115], v120, s[16:19], s4 offen offset:1280 sc1
    s_mov_b64 exec, -1
    s_waitcnt vmcnt(0)
    v_mfma_f32_32x32x16_bf16 v[0:15], v[104:107], v[96:99], v[16:31]
    s_nop 11
    v_exp_f32 v0, v0
    v_exp_f32 v1, v1
    v_exp_f32 v2, v2
    v_exp_f32 v3, v3
    v_exp_f32 v4, v4
    v_exp_f32 v5, v5
    v_exp_f32 v6, v6
    v_exp_f32 v7, v7
    v_exp_f32 v8, v8
    v_exp_f32 v9, v9
    v_exp_f32 v10, v10
    v_exp_f32 v11, v11
    v_exp_f32 v12, v12
    v_exp_f32 v13, v13
    v_exp_f32 v14, v14
    v_exp_f32 v15, v15
    s_nop 1
    v_smfmac_f32_32x32x32_bf16 v[64:79], v[108:111], v[0:7], v116
    v_smfmac_f32_32x32x32_bf16 v[64:79], v[112:115], v[8:15], v116
    s_add_u32 s4, s4, 2048
    s_sub_u32 s5, s5, 1
    s_cmp_lg_u32 s5, 0
    s_cbranch_scc1 L_fb_pv
    s_nop 11
    v_rcp_f32 v16, v72
    s_nop 0
    v_mul_f32 v64, v16, v64
    v_mul_f32 v65, v16, v65
    v_mul_f32 v66, v16, v66
    v_mul_f32 v67, v16, v67
    v_mul_f32 v68, v16, v68
    v_mul_f32 v69, v16, v69
    v_mul_f32 v70, v16, v70
    v_mul_f32 v71, v16, v71
    v_cvt_pk_bf16_f32 v80, v64, v65
    v_cvt_pk_bf16_f32 v81, v66, v67
    v_cvt_pk_bf16_f32 v82, v68, v69
    v_cvt_pk_bf16_f32 v83, v70, v71
    v_min_u32 v80, -2, v80
    v_min_u32 v81, -2, v81
    v_min_u32 v82, -2, v82
    v_min_u32 v83, -2, v83
    s_branch L_at_final
L_code_end:
    s_endpgm
.section .rodata,"a"
.p2align 6
.amdhsa_kernel concat_heads__spectral_fnet__softmax_full_mha__prompt_kernel
  .amdhsa_next_free_vgpr 256
  .amdhsa_next_free_sgpr 96
  .amdhsa_accum_offset 256
  .amdhsa_group_segment_fixed_size 0
  .amdhsa_kernarg_size 88
  .amdhsa_user_sgpr_count 2
  .amdhsa_user_sgpr_kernarg_segment_ptr 1
  .amdhsa_system_sgpr_workgroup_id_x 1
.end_amdhsa_kernel
```
